```python
import torch

def _softmax(x, axis=-1):
    return torch.softmax(x, dim=axis)
def _gelu(x):
    return torch.nn.functional.gelu(x, approximate="tanh")
def _silu(x):
    return torch.nn.functional.silu(x)
def _sigmoid(x):
    return torch.sigmoid(x)
def _layernorm(x, axis=-1, eps=1e-5):
    m = x.mean(dim=axis, keepdim=True)
    v = x.var(dim=axis, keepdim=True, unbiased=False)
    return (x - m) / torch.sqrt(v + eps)
def _scatter_add(tgt, idx, src, axis=0):
    return tgt.clone().index_add_(axis, idx, src)
def _segment_sum(src, seg, n):
    out = torch.zeros((n,) + src.shape[1:], dtype=src.dtype)
    return out.index_add_(0, seg, src)
def _pad(x, pw):
    flat = tuple(v for pair in reversed(pw) for v in pair)
    return torch.nn.functional.pad(x, flat)

kernel_name = 'interleave_layers__gqa_block_cached__compressed_kv_cla__decode'

def setup_inputs():

    _w = (lambda a: (lambda t: t.to(torch.bfloat16) if t.is_floating_point() else t)(torch.as_tensor(a)))
    def _A_setup():
        B, Sq, D = 1, 1, 640
        Hq, Hkv, Sk, Dh = 32, 32, 4096, 192
        assert Hq % Hkv == 0, (Hq, Hkv)
        return {
            "x": _w((lambda *s: torch.randn(*s, dtype=torch.bfloat16) * 0.05)(B, Sq, D)),
            "k_cache": _w((lambda *s: torch.randn(*s, dtype=torch.bfloat16) * 0.8)(B, Hkv, Sk, Dh)),
            "v_cache": _w((lambda *s: torch.randn(*s, dtype=torch.bfloat16) * 0.8)(B, Hkv, Sk, Dh)),
            "wq": _w((lambda *s: torch.randn(*s, dtype=torch.bfloat16) * 0.8)(D, Hq * Dh) * (D ** -0.5)),
            "wo": _w((lambda *s: torch.randn(*s, dtype=torch.bfloat16) * 0.8)(Hq * Dh, D) * ((Hq * Dh) ** -0.5)),
        }
    _A_in = _A_setup()

    def _B_setup():
        B, H, Sq, Sk, D, M = 1, 32, 1, 4096, 192, 640
        Dc = 4 * D
        return {
            "x": _w((lambda *s: torch.randn(*s, dtype=torch.bfloat16) * 0.05)(B, Sq, M)),
            "c_kv": _w((lambda *s: torch.randn(*s, dtype=torch.bfloat16) * 0.4)(B, Sk, Dc)),
            "w_q": _w((lambda *s: torch.randn(*s, dtype=torch.bfloat16) * 3.2)(M, H, D) * (M ** -0.5)),
            "w_uk": _w((lambda *s: torch.randn(*s, dtype=torch.bfloat16) * 3.2)(Dc, H, D) * (Dc ** -0.5)),
            "w_uv": _w((lambda *s: torch.randn(*s, dtype=torch.bfloat16) * 0.4)(Dc, H, D) * (Dc ** -0.5)),
            "w_o": _w((lambda *s: torch.randn(*s, dtype=torch.bfloat16) * 0.4)(H, D, M) * ((H * D) ** -0.5)),
        }
    _B_in = _B_setup()

    return {
        "A_x": _A_in["x"],
        "A_k_cache": _A_in["k_cache"],
        "A_v_cache": _A_in["v_cache"],
        "A_wq": _A_in["wq"],
        "A_wo": _A_in["wo"],
        "B_x": _B_in["x"],
        "B_c_kv": _B_in["c_kv"],
        "B_w_q": _B_in["w_q"],
        "B_w_uk": _B_in["w_uk"],
        "B_w_uv": _B_in["w_uv"],
        "B_w_o": _B_in["w_o"],
    }

def reference(A_x, A_k_cache, A_v_cache, A_wq, A_wo, B_x, B_c_kv, B_w_q, B_w_uk, B_w_uv, B_w_o):
    def _A_ref(x, k_cache, v_cache, wq, wo):
        B, Sq, D = x.shape
        Hq, Dh = 32, 192
        Hkv = k_cache.shape[1]
        rep = Hq // Hkv
        q = (lambda x, *d: x.permute(*d))((x @ wq).reshape(B, Sq, Hq, Dh), 0, 2, 1, 3)
        k = (lambda x, n, axis: torch.repeat_interleave(x, n, dim=axis))(k_cache, rep, axis=1)
        v = (lambda x, n, axis: torch.repeat_interleave(x, n, dim=axis))(v_cache, rep, axis=1)
        scores = torch.einsum("bhqd,bhkd->bhqk", q, k) * (Dh ** -0.5)
        p = _softmax(scores, axis=-1)
        o = torch.einsum("bhqk,bhkd->bhqd", p, v)
        return (lambda x, *d: x.permute(*d))(o, 0, 2, 1, 3).reshape(B, Sq, Hq * Dh) @ wo

    def _B_ref(x, c_kv, w_q, w_uk, w_uv, w_o):
        B, Sq, M = x.shape[0], x.shape[1], x.shape[2]
        Sk = c_kv.shape[1]
        H, D = w_q.shape[1], w_q.shape[2]
        q = torch.einsum("bqm,mhd->bhqd", x, w_q)
        k = torch.einsum("bkc,chd->bhkd", c_kv, w_uk)
        v = torch.einsum("bkc,chd->bhkd", c_kv, w_uv)
        scores = torch.einsum("bhqd,bhkd->bhqk", q, k) * (D ** -0.5)
        off = Sk - Sq
        qi = torch.arange(Sq)[:, None]
        kj = torch.arange(Sk)[None, :]
        cmask = kj <= (qi + off)
        scores = torch.where(cmask[None, None], scores, -1e9)
        p = _softmax(scores, axis=-1)
        ctx = torch.einsum("bhqk,bhkd->bhqd", p, v)
        return torch.einsum("bhqd,hdm->bqm", ctx, w_o)

    x = A_x
    x = x + _A_ref(_layernorm(x, axis=-1), A_k_cache, A_v_cache, A_wq, A_wo)
    x = x + _B_ref(_layernorm(x, axis=-1), B_c_kv, B_w_q, B_w_uk, B_w_uv, B_w_o)
    x = x + _A_ref(_layernorm(x, axis=-1), A_k_cache, A_v_cache, A_wq, A_wo)
    x = x + _B_ref(_layernorm(x, axis=-1), B_c_kv, B_w_q, B_w_uk, B_w_uv, B_w_o)
    return x
```

```asm
; @launch grid=(256,1,1) block=(256,1,1) lds=163840
.amdgcn_target "amdgcn-amd-amdhsa--gfx950"
.text
.globl interleave_layers__gqa_block_cached__compressed_kv_cla__decode_kernel
.p2align 8
.type interleave_layers__gqa_block_cached__compressed_kv_cla__decode_kernel,@function
interleave_layers__gqa_block_cached__compressed_kv_cla__decode_kernel:
    s_cmp_ge_u32 s2, 256
    s_cbranch_scc1 L_end
    s_load_dwordx16 s[64:79], s[0:1], 0
    s_load_dwordx8 s[80:87], s[0:1], 64
    s_load_dwordx4 s[88:91], s[0:1], 96
    v_lshrrev_b32 v1, 6, v0
    v_mov_b32 v51, v0
    v_and_b32 v0, 63, v0
    v_readfirstlane_b32 s9, v1
    s_and_b32 s28, s2, 7
    s_lshl_b32 s28, s28, 5
    s_lshr_b32 s29, s2, 3
    s_add_u32 s4, s28, s29
    s_lshr_b32 s5, s4, 3
    s_and_b32 s6, s4, 7
    s_mul_i32 s11, s5, 1572864
    s_lshl_b32 s28, s6, 2
    s_add_u32 s28, s28, s9
    s_mul_i32 s28, s28, 49152
    s_add_u32 s11, s11, s28
    s_mov_b32 s49, 0
    v_lshrrev_b32 v45, 3, v0
    v_and_b32 v1, 6, v45
    v_xor_b32 v1, v1, v0
    v_and_b32 v1, 7, v1
    v_mul_u32_u24 v45, 384, v45
    v_lshl_add_u32 v45, v1, 4, v45
    v_and_b32 v1, 32, v0
    v_lshrrev_b32 v1, 4, v1
    v_and_b32 v2, 16, v0
    v_lshrrev_b32 v2, 2, v2
    v_or_b32 v1, v2, v1
    v_and_b32 v2, 8, v0
    v_lshl_or_b32 v1, v2, 1, v1
    v_mul_u32_u24 v1, 384, v1
    v_and_b32 v2, 0x70, v45
    v_add_u32 v44, v1, v2
    s_mul_i32 s57, s9, 30720
    s_add_u32 s57, s57, 30720
    s_waitcnt lgkmcnt(0)
    s_mov_b32 s24, s70
    s_mov_b32 s25, s71
    s_mov_b32 s26, 7864320
    s_mov_b32 s27, 0x00020000
    s_mul_i32 s54, s6, 983040
    s_mul_i32 s55, s5, 384
    s_add_u32 s54, s54, s55
    v_lshrrev_b32 v1, 3, v0
    v_and_b32 v2, 6, v1
    v_xor_b32 v2, v2, v0
    v_and_b32 v2, 7, v2
    v_mul_u32_u24 v1, 12288, v1
    v_lshl_add_u32 v1, v2, 4, v1
    s_add_u32 s55, s9, 0
    s_lshl_b32 s56, s55, 10
    s_add_u32 m0, s56, 0
    s_mul_i32 s56, s55, 43
    s_lshr_b32 s56, s56, 7
    s_mul_i32 s56, s56, 97920
    s_lshl_b32 s55, s55, 7
    s_add_u32 s56, s56, s55
    s_add_u32 s56, s56, s54
    buffer_load_dwordx4 v1, s[24:27], s56 offen nt lds
    s_add_u32 s55, s9, 4
    s_lshl_b32 s56, s55, 10
    s_add_u32 m0, s56, 0
    s_mul_i32 s56, s55, 43
    s_lshr_b32 s56, s56, 7
    s_mul_i32 s56, s56, 97920
    s_lshl_b32 s55, s55, 7
    s_add_u32 s56, s56, s55
    s_add_u32 s56, s56, s54
    buffer_load_dwordx4 v1, s[24:27], s56 offen nt lds
    s_add_u32 s55, s9, 8
    s_lshl_b32 s56, s55, 10
    s_add_u32 m0, s56, 0
    s_mul_i32 s56, s55, 43
    s_lshr_b32 s56, s56, 7
    s_mul_i32 s56, s56, 97920
    s_lshl_b32 s55, s55, 7
    s_add_u32 s56, s56, s55
    s_add_u32 s56, s56, s54
    buffer_load_dwordx4 v1, s[24:27], s56 offen nt lds
    s_add_u32 s55, s9, 12
    s_lshl_b32 s56, s55, 10
    s_add_u32 m0, s56, 0
    s_mul_i32 s56, s55, 43
    s_lshr_b32 s56, s56, 7
    s_mul_i32 s56, s56, 97920
    s_lshl_b32 s55, s55, 7
    s_add_u32 s56, s56, s55
    s_add_u32 s56, s56, s54
    buffer_load_dwordx4 v1, s[24:27], s56 offen nt lds
    s_add_u32 s55, s9, 16
    s_lshl_b32 s56, s55, 10
    s_add_u32 m0, s56, 0
    s_mul_i32 s56, s55, 43
    s_lshr_b32 s56, s56, 7
    s_mul_i32 s56, s56, 97920
    s_lshl_b32 s55, s55, 7
    s_add_u32 s56, s56, s55
    s_add_u32 s56, s56, s54
    buffer_load_dwordx4 v1, s[24:27], s56 offen nt lds
    s_add_u32 s55, s9, 20
    s_lshl_b32 s56, s55, 10
    s_add_u32 m0, s56, 0
    s_mul_i32 s56, s55, 43
    s_lshr_b32 s56, s56, 7
    s_mul_i32 s56, s56, 97920
    s_lshl_b32 s55, s55, 7
    s_add_u32 s56, s56, s55
    s_add_u32 s56, s56, s54
    buffer_load_dwordx4 v1, s[24:27], s56 offen nt lds
    s_add_u32 s55, s9, 24
    s_lshl_b32 s56, s55, 10
    s_add_u32 m0, s56, 0
    s_mul_i32 s56, s55, 43
    s_lshr_b32 s56, s56, 7
    s_mul_i32 s56, s56, 97920
    s_lshl_b32 s55, s55, 7
    s_add_u32 s56, s56, s55
    s_add_u32 s56, s56, s54
    buffer_load_dwordx4 v1, s[24:27], s56 offen nt lds
    s_and_b32 s55, s9, 1
    s_add_u32 s55, s55, 28
    s_lshl_b32 s56, s55, 10
    s_add_u32 m0, s56, 0
    s_mul_i32 s56, s55, 43
    s_lshr_b32 s56, s56, 7
    s_mul_i32 s56, s56, 97920
    s_lshl_b32 s55, s55, 7
    s_add_u32 s56, s56, s55
    s_add_u32 s56, s56, s54
    buffer_load_dwordx4 v1, s[24:27], s56 offen nt lds
    s_mov_b32 s12, s66
    s_mov_b32 s13, s67
    s_mov_b32 s14, 50331648
    s_mov_b32 s15, 0x00020000
    s_cmp_lt_u32 s9, 2
    s_cselect_b32 s55, 63, 59
    s_min_u32 s54, s9, 2
    s_lshl_b32 s54, s54, 3
    v_and_b32 v54, s55, v0
    v_and_b32 v60, 7, v54
    v_lshlrev_b32 v54, 4, v54
    v_add_u32 v60, s54, v60
    v_and_b32 v3, s55, v0
    v_cmp_eq_u32 s[58:59], v3, v0
    v_lshrrev_b32 v55, 4, v0
    v_lshl_add_u32 v60, v60, 2, v55
    v_and_b32 v55, 16, v60
    v_lshrrev_b32 v55, 2, v55
    v_and_b32 v3, 37, v60
    v_lshl_or_b32 v55, v3, 1, v55
    v_and_b32 v3, 8, v60
    v_lshl_or_b32 v55, v3, 2, v55
    v_and_b32 v3, 2, v60
    v_lshl_or_b32 v55, v3, 3, v55
    v_cmp_gt_u32 vcc, 64, v60
    v_lshlrev_b32 v60, 1, v60
    s_nop 0
    v_cndmask_b32 v55, v60, v55, vcc
    v_add_u32 v55, 161792, v55
    s_mov_b32 s24, s64
    s_mov_b32 s25, s65
    s_mov_b32 s26, 1280
    s_mov_b32 s27, 0x00020000
    s_mul_i32 s28, s6, 160
    buffer_load_ushort v20, v60, s[24:27], s28 offen
    s_add_u32 m0, s57, 0
    s_add_u32 s35, s11, 0
    buffer_load_dwordx4 v44, s[12:15], s35 offen nt lds
    s_add_u32 m0, s57, 1024
    s_add_u32 s35, s11, 128
    buffer_load_dwordx4 v44, s[12:15], s35 offen nt lds
    s_add_u32 m0, s57, 2048
    s_add_u32 s35, s11, 256
    buffer_load_dwordx4 v44, s[12:15], s35 offen nt lds
    s_add_u32 m0, s57, 3072
    s_add_u32 s35, s11, 3072
    buffer_load_dwordx4 v44, s[12:15], s35 offen nt lds
    s_add_u32 m0, s57, 4096
    s_add_u32 s35, s11, 3200
    buffer_load_dwordx4 v44, s[12:15], s35 offen nt lds
    s_add_u32 m0, s57, 5120
    s_add_u32 s35, s11, 3328
    buffer_load_dwordx4 v44, s[12:15], s35 offen nt lds
    s_add_u32 m0, s57, 6144
    s_add_u32 s35, s11, 384
    buffer_load_dwordx4 v44, s[12:15], s35 offen nt lds
    s_add_u32 m0, s57, 7168
    s_add_u32 s35, s11, 512
    buffer_load_dwordx4 v44, s[12:15], s35 offen nt lds
    s_add_u32 m0, s57, 8192
    s_add_u32 s35, s11, 640
    buffer_load_dwordx4 v44, s[12:15], s35 offen nt lds
    s_add_u32 m0, s57, 9216
    s_add_u32 s35, s11, 3456
    buffer_load_dwordx4 v44, s[12:15], s35 offen nt lds
    s_add_u32 m0, s57, 10240
    s_add_u32 s35, s11, 3584
    buffer_load_dwordx4 v44, s[12:15], s35 offen nt lds
    s_add_u32 m0, s57, 11264
    s_add_u32 s35, s11, 3712
    buffer_load_dwordx4 v44, s[12:15], s35 offen nt lds
    s_mov_b32 s16, s68
    s_mov_b32 s17, s69
    s_mov_b32 s18, 50331648
    s_mov_b32 s19, 0x00020000
    s_mov_b32 s20, s90
    s_mov_b32 s21, s91
    s_mov_b32 s22, 16777216
    s_mov_b32 s23, 0x00020000
    s_add_u32 s96, s90, 5046272
    s_addc_u32 s97, s91, 0
    s_load_dword s62, s[96:97], 0
    s_getpc_b64 s[98:99]
L_pc:
    s_lshr_b32 s28, s2, 3
    s_lshl_b32 s28, s28, 2
    s_add_u32 s28, s28, s9
    s_lshl_b32 s28, s28, 8
    s_min_u32 s28, s28, L_last-L_pc-132
    s_add_u32 s98, s98, s28
    s_addc_u32 s99, s99, 0
    s_lshr_b32 s7, s4, 2
    s_and_b32 s8, s4, 3
    s_mov_b32 s10, 0
    s_mov_b32 s3, 0
    s_mov_b32 s36, -1
    s_mov_b32 s37, 0xffff
    s_mov_b32 s38, 0xffff
    s_mov_b32 s39, 0
    s_mov_b64 s[40:41], 1
    s_mov_b32 s42, -1
    s_mov_b32 s43, 0x0fffffff
    s_mov_b32 s50, -1
    s_mov_b32 s51, 0
    s_mov_b32 s44, 1037384597
    s_mov_b32 s47, 1048576
    s_mov_b32 s60, -1
    s_mov_b32 s93, 0
    s_mov_b32 s92, 0x55555555
    s_cmp_lt_u32 s9, 2
    s_cselect_b32 s61, 0, -1
    s_cselect_b32 s92, s92, 0x5555
    s_cmp_eq_u32 s9, 2
    s_cselect_b32 s0, 0.5, 1.0
    s_cmp_eq_u32 s9, 3
    s_cselect_b32 s1, 67108864, 0
    s_lshl_b32 s52, s5, 16
    s_lshl_b32 s28, s9, 11
    s_add_u32 s52, s52, s28
    s_add_u32 s52, s52, 8192
    s_mul_i32 s46, s6, 12288
    s_add_u32 s46, s46, 4096000
    s_lshl_b32 s45, s5, 7
    s_add_u32 s45, s45, s46
    s_lshr_b32 s28, s9, 1
    s_lshl_b32 s28, s28, 12
    s_add_u32 s45, s45, s28
    s_and_b32 s28, s9, 1
    s_lshl_b32 s28, s28, 6
    s_add_u32 s45, s45, s28
    s_lshl_b32 s28, s9, 12
    s_add_u32 s46, s46, s28
    s_lshr_b32 s28, s6, 1
    s_lshl_b32 s28, s28, 1
    s_lshr_b32 s29, s5, 4
    s_add_u32 s28, s28, s29
    s_lshl_b32 s28, s28, 1
    s_and_b32 s29, s6, 1
    s_add_u32 s28, s28, s29
    s_mul_i32 s28, s28, 3
    s_min_u32 s29, s9, 2
    s_add_u32 s28, s28, s29
    s_lshl_b32 s63, s28, 10
    s_and_b32 s28, s5, 15
    s_lshl_b32 s28, s28, 6
    s_add_u32 s63, s63, s28
    s_sub_u32 s28, s9, s29
    s_lshl_b32 s28, s28, 5
    s_add_u32 s63, s63, s28
    s_add_u32 s63, s63, 4718592
    s_and_b32 s29, s9, 1
    s_lshr_b32 s30, s9, 1
    s_lshl_b32 s28, s8, 1
    s_add_u32 s28, s28, s29
    s_mul_i32 s94, s28, 6144
    s_add_u32 s94, s94, 4718592
    s_lshl_b32 s95, s4, 13
    s_lshl_b32 s28, s9, 11
    s_add_u32 s95, s95, s28
    s_add_u32 s95, s95, 5242880
    s_lshl_b32 s28, s29, 6
    s_lshl_b32 s31, s8, 1
    s_add_u32 s28, s28, s31
    s_add_u32 s28, s28, s30
    s_lshl_b32 s28, s28, 6
    s_add_u32 s28, s28, s7
    s_mul_i32 s98, s28, 384
    s_add_u32 s98, s98, 9437184
    s_lshr_b32 s28, s5, 1
    s_lshl_b32 s28, s28, 3
    s_add_u32 s28, s28, s6
    s_mul_i32 s99, s28, 24576
    s_and_b32 s28, s5, 1
    s_lshl_b32 s28, s28, 6
    s_add_u32 s99, s99, s28
    s_lshl_b32 s28, s9, 7
    s_add_u32 s99, s99, s28
    s_add_u32 s99, s99, 9437184
    s_lshl_b32 s100, s4, 8
    s_lshl_b32 s28, s29, 7
    s_add_u32 s100, s100, s28
    s_mul_i32 s28, s30, 67108864
    s_add_u32 s100, s100, s28
    s_add_u32 s100, s100, 4849664
    s_lshr_b32 s28, s6, 1
    s_lshl_b32 s101, s28, 8
    s_lshl_b32 s28, s5, 3
    s_add_u32 s101, s101, s28
    s_add_u32 s101, s101, 4849664
    v_lshlrev_b32 v1, 2, v0
    v_min_u32 v1, 156, v1
    v_add_u32 v1, 161984, v1
    v_mov_b32 v2, 0x3f803f80
    v_mov_b32 v3, 0
    ds_write_b32 v1, v2
    ds_write_b32 v1, v3 offset:160
    v_mov_b32 v1, 162896
    ds_write_b32 v1, v3
    v_and_b32 v3, 1, v0
    v_lshlrev_b32 v3, 4, v3
    v_lshrrev_b32 v1, 4, v0
    v_lshl_add_u32 v1, v1, 5, v3
    v_and_b32 v3, 2, v0
    v_mul_u32_u24 v3, 96, v3
    v_add_u32 v3, 161792, v3
    v_add_u32 v1, v1, v3
    v_lshrrev_b32 v2, 4, v0
    v_lshl_add_u32 v2, v2, 3, v3
    v_add_u32 v2, 128, v2
    v_and_b32 v3, 1, v0
    v_cmp_eq_u32 vcc, 1, v3
    v_mov_b32 v3, 162144
    s_nop 0
    v_cndmask_b32 v2, v2, v3, vcc
    v_and_b32 v4, 1, v0
    v_mul_u32_u24 v4, 0xaaaa, v4
    v_or_b32 v4, 0x4444, v4
    s_lshl_b32 s54, s9, 5
    s_lshl_b32 s55, s9, 6
    s_sub_u32 s55, s55, 64
    s_cmp_lt_u32 s9, 2
    s_cselect_b32 s54, s54, s55
    v_add_u32 v5, s54, v0
    v_lshrrev_b32 v3, 6, v5
    v_mul_u32_u24 v3, 448, v3
    s_lshl_b32 s55, s6, 8
    s_lshl_b32 s56, s9, 11
    s_sub_u32 s55, s55, s56
    s_add_u32 s55, s55, 8192
    v_add_lshl_u32 v5, v5, v3, 2
    v_add_u32 v5, s55, v5
    s_add_u32 s32, s52, 4294959104
    s_mul_i32 s33, s9, 4294965252
    s_lshl_b32 s55, s6, 5
    s_add_u32 s33, s33, s55
    s_add_u32 s33, s33, s52
    s_add_u32 s33, s33, 6144
    s_add_u32 s33, s33, s1
    v_bfe_u32 v42, v0, 2, 3
    v_and_b32 v3, 6, v42
    v_lshlrev_b32 v42, 7, v42
    v_lshl_add_u32 v42, v3, 4, v42
    v_and_b32 v3, 3, v0
    v_lshl_add_u32 v42, v3, 3, v42
    v_lshrrev_b32 v3, 5, v0
    v_mul_u32_u24 v3, 3072, v3
    v_add_u32 v42, v42, v3
    s_waitcnt vmcnt(12)
    ds_write_b16 v55, v20
    s_waitcnt lgkmcnt(0)
    s_barrier
    s_add_u32 s62, s62, 1
    s_lshl_b32 s54, s9, 1
    s_lshl_b32 s55, s9, 2
    s_sub_u32 s55, s55, 4
    s_cmp_lt_u32 s9, 2
    s_cselect_b32 s54, s54, s55
    s_add_u32 s54, s54, 0
    s_and_b32 s55, s54, 3
    s_lshl_b32 s55, s55, 5
    s_lshr_b32 s56, s54, 2
    s_lshl_b32 s56, s56, 10
    s_add_u32 s56, s56, 0
    v_xor_b32 v43, s55, v42
    v_add_u32 v43, s56, v43
    ds_read_b64_tr_b16 a[240:241], v43 offset:0
    ds_read_b64_tr_b16 a[242:243], v43 offset:6144
    ds_read_b64_tr_b16 a[244:245], v43 offset:12288
    ds_read_b64_tr_b16 a[246:247], v43 offset:18432
    ds_read_b64_tr_b16 v[56:57], v43 offset:24576
    s_lshl_b32 s54, s9, 1
    s_lshl_b32 s55, s9, 2
    s_sub_u32 s55, s55, 4
    s_cmp_lt_u32 s9, 2
    s_cselect_b32 s54, s54, s55
    s_add_u32 s54, s54, 1
    s_and_b32 s55, s54, 3
    s_lshl_b32 s55, s55, 5
    s_lshr_b32 s56, s54, 2
    s_lshl_b32 s56, s56, 10
    s_add_u32 s56, s56, 0
    v_xor_b32 v43, s55, v42
    v_add_u32 v43, s56, v43
    ds_read_b64_tr_b16 a[248:249], v43 offset:0
    ds_read_b64_tr_b16 a[250:251], v43 offset:6144
    ds_read_b64_tr_b16 a[252:253], v43 offset:12288
    ds_read_b64_tr_b16 a[254:255], v43 offset:18432
    ds_read_b64_tr_b16 v[58:59], v43 offset:24576
    s_lshl_b32 s54, s9, 1
    s_lshl_b32 s55, s9, 2
    s_sub_u32 s55, s55, 4
    s_cmp_lt_u32 s9, 2
    s_cselect_b32 s54, s54, s55
    s_add_u32 s54, s54, 2
    s_and_b32 s55, s54, 3
    s_lshl_b32 s55, s55, 5
    s_lshr_b32 s56, s54, 2
    s_lshl_b32 s56, s56, 10
    s_add_u32 s56, s56, 0
    v_xor_b32 v43, s55, v42
    v_add_u32 v43, s56, v43
    ds_read_b64_tr_b16 a[216:217], v43 offset:0
    ds_read_b64_tr_b16 a[218:219], v43 offset:6144
    ds_read_b64_tr_b16 a[220:221], v43 offset:12288
    ds_read_b64_tr_b16 a[222:223], v43 offset:18432
    ds_read_b64_tr_b16 a[232:233], v43 offset:24576
    s_lshl_b32 s54, s9, 1
    s_lshl_b32 s55, s9, 2
    s_sub_u32 s55, s55, 4
    s_cmp_lt_u32 s9, 2
    s_cselect_b32 s54, s54, s55
    s_add_u32 s54, s54, 3
    s_and_b32 s55, s54, 3
    s_lshl_b32 s55, s55, 5
    s_lshr_b32 s56, s54, 2
    s_lshl_b32 s56, s56, 10
    s_add_u32 s56, s56, 0
    v_xor_b32 v43, s55, v42
    v_add_u32 v43, s56, v43
    ds_read_b64_tr_b16 a[224:225], v43 offset:0
    ds_read_b64_tr_b16 a[226:227], v43 offset:6144
    ds_read_b64_tr_b16 a[228:229], v43 offset:12288
    ds_read_b64_tr_b16 a[230:231], v43 offset:18432
    ds_read_b64_tr_b16 a[234:235], v43 offset:24576
    v_lshlrev_b32 v3, 16, v20
    v_cndmask_b32 v3, 0, v3, s[58:59]
    s_nop 1
    v_mul_f32_dpp v3, v3, v3 quad_perm:[0,1,2,3] row_mask:0xf bank_mask:0x3
    s_waitcnt lgkmcnt(0)
L_top:
    ds_read_b64 v[10:11], v2
    ds_read_b128 v[6:9], v1
    v_add_f32_dpp v3, v3, v3 quad_perm:[1,0,3,2] row_mask:0xf bank_mask:0xf
    v_lshlrev_b32 v54, 2, v0
    v_and_b32 v55, 7, v0
    v_add_f32_dpp v3, v3, v3 quad_perm:[2,3,0,1] row_mask:0xf bank_mask:0xf
    s_lshl_b32 s54, s9, 11
    s_sub_u32 s54, 6144, s54
    v_add_f32_dpp v3, v3, v3 row_half_mirror row_mask:0xf bank_mask:0xf
    v_lshl_add_u32 v55, v55, 5, s54
    v_mov_b32 v2, v3
    s_waitcnt lgkmcnt(1)
    v_mfma_f32_16x16x16_bf16 v[24:27], v[10:11], v[56:57], 0
    v_permlane16_swap_b32 v3, v2
    v_add_f32 v3, v3, v2
    v_mfma_f32_16x16x16_bf16 v[28:31], v[10:11], v[58:59], 0
    v_mov_b32 v2, v3
    v_and_b32 v1, 8, v0
    v_mfma_f32_16x16x16_bf16 v[32:35], v[10:11], a[232:233], 0
    v_permlane32_swap_b32 v3, v2
    v_add_f32 v3, v3, v2
    v_mfma_f32_16x16x16_bf16 v[36:39], v[10:11], a[234:235], 0
    v_lshlrev_b32 v1, 1, v1
    v_sub_u32 v1, 16, v1
    s_waitcnt lgkmcnt(0)
    v_smfmac_f32_16x16x64_bf16 v[24:27], v[6:9], a[240:247], v4
    s_add_u32 s28, s32, 8192
    s_add_u32 s45, s45, 98304
    v_smfmac_f32_16x16x64_bf16 v[28:31], v[6:9], a[248:255], v4
    s_add_u32 s46, s46, 98304
    v_smfmac_f32_16x16x64_bf16 v[32:35], v[6:9], a[216:223], v4
    v_smfmac_f32_16x16x64_bf16 v[36:39], v[6:9], a[224:231], v4
    s_cmp_eq_u32 s10, 0
    s_nop 2
    s_cbranch_scc1 Lx_1
    s_cmp_eq_u32 s3, 0
    s_cbranch_scc1 Lx_3
    s_mov_b64 exec, 0x101
    buffer_store_dword v3, v1, s[20:23], s33 offen
    s_mov_b64 exec, s[60:61]
    v_add_f32_dpp v2, v24, v25 quad_perm:[0,1,2,3] row_mask:0x1 bank_mask:0xf
    v_add_f32_dpp v2, v28, v29 quad_perm:[0,1,2,3] row_mask:0x2 bank_mask:0xf
    v_add_f32_dpp v2, v32, v33 quad_perm:[0,1,2,3] row_mask:0x4 bank_mask:0xf
    v_add_f32_dpp v2, v36, v37 quad_perm:[0,1,2,3] row_mask:0x8 bank_mask:0xf
    buffer_store_dword v2, v5, s[20:23], s32 offen
    s_mov_b64 exec, -1
Lr_4:
Lr_2:
    s_cmp_eq_u32 s10, 0
    s_cbranch_scc1 Lx_6
Lr_7:
    s_cmp_eq_u32 s9, 3
    s_cbranch_scc1 Lx_65
    s_sleep 4
    buffer_load_dwordx3 v[12:14], v55, s[20:23], s28 offen sc1
    buffer_load_dwordx3 v[16:18], v55, s[20:23], s28 offen offset:16 sc1
    buffer_load_dword v4, v54, s[20:23], s28 offen offset:0 sc1
    buffer_load_dword v5, v54, s[20:23], s28 offen offset:256 sc1
    buffer_load_dword v6, v54, s[20:23], s28 offen offset:512 sc1
    buffer_load_dword v7, v54, s[20:23], s28 offen offset:768 sc1
    buffer_load_dword v8, v54, s[20:23], s28 offen offset:1024 sc1
    buffer_load_dword v9, v54, s[20:23], s28 offen offset:1280 sc1
    buffer_load_dword v10, v54, s[20:23], s28 offen offset:1536 sc1
    buffer_load_dword v11, v54, s[20:23], s28 offen offset:1792 sc1
    s_mov_b32 s53, 0
    s_lshl_b32 s54, s9, 7
    s_add_u32 s54, s54, 162304
    v_and_b32 v2, 12, v0
    v_and_b32 v3, 49, v0
    v_lshl_or_b32 v2, v3, 1, v2
    v_and_b32 v3, 2, v0
    v_lshl_or_b32 v2, v3, 3, v2
    v_add_u32 v2, s54, v2
    v_and_b32 v53, 1, v0
    v_lshlrev_b32 v53, 4, v53
    v_lshrrev_b32 v52, 4, v0
    v_lshl_add_u32 v52, v52, 5, v53
    v_add_u32 v52, 162304, v52
    v_and_b32 v53, 1, v0
    v_mul_u32_u24 v53, 0xaaaa, v53
    v_or_b32 v53, 0x4444, v53
    v_lshlrev_b32 v60, 4, v0
    s_xor_b32 s54, s10, 1
    s_mul_i32 s54, s54, 67108864
    s_add_u32 s33, s95, s54
    s_and_b32 s55, s5, 1
    s_mul_i32 s55, s55, 12224
    s_add_u32 s54, s54, s55
    s_mul_i32 s55, s9, 2944
    s_add_u32 s54, s54, s55
    s_add_u32 s32, s99, s54
    s_cmp_eq_u32 s10, 0
    s_cbranch_scc1 Ls_70
    v_mov_b64 v[20:21], 0
    v_mov_b64 v[24:25], 0
    v_mov_b64 v[28:29], 0
    v_mov_b64 v[32:33], 0
    v_mov_b64 v[36:37], 0
    v_mov_b64 v[40:41], 0
    v_mov_b64 v[44:45], 0
    v_mov_b64 v[48:49], 0
Ls_70:
    s_cmp_eq_u32 s10, 0
    s_cbranch_scc1 Lx_71
    s_waitcnt vmcnt(8)
    v_add_f32 v12, v12, v13
    v_add_f32 v12, v12, v14
    v_add_f32 v16, v16, v17
    v_add_f32 v16, v16, v18
    v_add_f32_dpp v12, v12, v12 quad_perm:[1,0,3,2] row_mask:0xf bank_mask:0xf
    s_nop 1
    v_add_f32_dpp v12, v12, v12 quad_perm:[2,3,0,1] row_mask:0xf bank_mask:0xf
    s_nop 1
    v_add_f32_dpp v12, v12, v12 row_half_mirror row_mask:0xf bank_mask:0xf
    s_waitcnt vmcnt(0)
Lc2_72:
    v_pk_add_f32 v[4:5], v[4:5], v[6:7]
    v_pk_add_f32 v[8:9], v[8:9], v[10:11]
    v_pk_add_f32 v[4:5], v[4:5], v[8:9]
    v_add_f32 v4, v4, v5
    v_fma_f32 v4, -v12, v61, v4
    v_cvt_pk_bf16_f32 v5, v4, v4
    ds_write_b16 v2, v5
    v_cmp_u_f32 vcc, v4, v16
    s_cbranch_vccnz Lcold_69
Lok_68:
Lr_66:
    s_waitcnt lgkmcnt(0)
    s_barrier
    ds_read_b128 v[4:7], v52
    ds_read_b128 v[8:11], v52 offset:128
    v_add_f32_dpp v16, v16, v16 quad_perm:[1,0,3,2] row_mask:0xf bank_mask:0xf
    v_mul_f32 v12, 986500301, v12
    v_mov_b32 v13, 162880
    v_add_f32_dpp v16, v16, v16 quad_perm:[2,3,0,1] row_mask:0xf bank_mask:0xf
    v_mul_f32 v12, v12, v12
    s_min_u32 s54, s9, 1
    v_add_f32_dpp v16, v16, v16 row_half_mirror row_mask:0xf bank_mask:0xf
    s_lshl_b32 s54, s54, 5
    s_waitcnt lgkmcnt(1)
    v_smfmac_f32_16x16x64_bf16 v[20:23], v[4:7], a[0:7], v53
    v_mul_f32 v16, 986500301, v16
    v_sub_f32 v16, v16, v12
    v_smfmac_f32_16x16x64_bf16 v[24:27], v[4:7], a[24:31], v53
    v_max_f32 v16, 0, v16
    v_add_f32 v16, 925353388, v16
    v_smfmac_f32_16x16x64_bf16 v[28:31], v[4:7], a[48:55], v53
    v_rsq_f32 v16, v16
    v_add_u32 v13, s54, v13
    v_smfmac_f32_16x16x64_bf16 v[32:35], v[4:7], a[72:79], v53
    v_mul_f32 v16, s44, v16
    ds_write_b32 v13, v16
    v_smfmac_f32_16x16x64_bf16 v[36:39], v[4:7], a[96:103], v53
    v_smfmac_f32_16x16x64_bf16 v[40:43], v[4:7], a[120:127], v53
    v_smfmac_f32_16x16x64_bf16 v[44:47], v[4:7], a[144:151], v53
    v_mov_b64 v[18:19], -1
    v_smfmac_f32_16x16x64_bf16 v[48:51], v[4:7], a[168:175], v53
    v_mov_b64 v[16:17], -1
    ds_read_b128 v[4:7], v52 offset:256
    s_waitcnt lgkmcnt(1)
    v_smfmac_f32_16x16x64_bf16 v[20:23], v[8:11], a[8:15], v53
    s_barrier
    v_mov_b32 v13, 162880
    ds_read_b96 v[12:14], v13
    v_smfmac_f32_16x16x64_bf16 v[24:27], v[8:11], a[32:39], v53
    buffer_store_dwordx4 v[16:19], v60, s[20:23], s33 offen offset:0 sc1
    v_smfmac_f32_16x16x64_bf16 v[28:31], v[8:11], a[56:63], v53
    s_lshl_b32 s54, s9, 8
    s_add_u32 s54, s54, 157696
    v_smfmac_f32_16x16x64_bf16 v[32:35], v[8:11], a[80:87], v53
    v_lshl_add_u32 v54, v0, 2, s54
    s_sub_u32 s54, s54, 162304
    v_smfmac_f32_16x16x64_bf16 v[36:39], v[8:11], a[104:111], v53
    v_add_u32 v52, s54, v52
    v_and_b32 v15, 2, v0
    v_smfmac_f32_16x16x64_bf16 v[40:43], v[8:11], a[128:135], v53
    v_cmp_eq_u32 vcc, 0, v15
    v_mov_b32 v15, 162144
    v_smfmac_f32_16x16x64_bf16 v[44:47], v[8:11], a[152:159], v53
    buffer_store_dwordx4 v[16:19], v60, s[20:23], s33 offen offset:1024 sc1
    v_smfmac_f32_16x16x64_bf16 v[48:51], v[8:11], a[176:183], v53
    v_cndmask_b32 v55, v52, v15, vcc
    v_cndmask_b32 v52, v15, v52, vcc
    s_waitcnt lgkmcnt(1)
    v_smfmac_f32_16x16x64_bf16 v[20:23], v[4:7], a[16:23], v53
    s_nop 1
    v_smfmac_f32_16x16x64_bf16 v[24:27], v[4:7], a[40:47], v53
    s_nop 1
    v_smfmac_f32_16x16x64_bf16 v[28:31], v[4:7], a[64:71], v53
    buffer_store_dwordx4 v[16:19], v60, s[20:23], s32 offen offset:0 sc1
    s_nop 1
    v_smfmac_f32_16x16x64_bf16 v[32:35], v[4:7], a[88:95], v53
    s_nop 1
    v_smfmac_f32_16x16x64_bf16 v[36:39], v[4:7], a[112:119], v53
    s_nop 0
    v_add_f32_dpp v1, v20, v21 quad_perm:[0,1,2,3] row_mask:0x1 bank_mask:0xf
    v_smfmac_f32_16x16x64_bf16 v[40:43], v[4:7], a[136:143], v53
    s_nop 0
    v_add_f32_dpp v2, v24, v25 quad_perm:[0,1,2,3] row_mask:0x1 bank_mask:0xf
    v_smfmac_f32_16x16x64_bf16 v[44:47], v[4:7], a[160:167], v53
    s_nop 0
    v_add_f32_dpp v1, v28, v29 quad_perm:[0,1,2,3] row_mask:0x2 bank_mask:0xf
    v_smfmac_f32_16x16x64_bf16 v[48:51], v[4:7], a[184:191], v53
    s_nop 0
    v_add_f32_dpp v2, v32, v33 quad_perm:[0,1,2,3] row_mask:0x2 bank_mask:0xf
    v_mov_b64 v[20:21], 0
    v_add_f32_dpp v1, v36, v37 quad_perm:[0,1,2,3] row_mask:0x4 bank_mask:0xf
    v_mov_b64 v[22:23], 0
    v_add_f32_dpp v2, v40, v41 quad_perm:[0,1,2,3] row_mask:0x4 bank_mask:0xf
    v_mov_b64 v[24:25], 0
    v_mov_b64 v[26:27], 0
    v_add_f32_dpp v1, v44, v45 quad_perm:[0,1,2,3] row_mask:0x8 bank_mask:0xf
    v_mov_b64 v[28:29], 0
    v_mov_b64 v[30:31], 0
    v_add_f32_dpp v2, v48, v49 quad_perm:[0,1,2,3] row_mask:0x8 bank_mask:0xf
    v_max_f32 v3, v1, v2
    s_waitcnt lgkmcnt(0)
    v_mov_b64 v[32:33], 0
    v_max_f32_dpp v3, v3, v3 quad_perm:[1,0,3,2] row_mask:0xf bank_mask:0xf
    v_mov_b64 v[34:35], 0
    v_mov_b64 v[36:37], 0
    v_max_f32_dpp v3, v3, v3 quad_perm:[2,3,0,1] row_mask:0xf bank_mask:0xf
    v_mov_b64 v[38:39], 0
    v_mov_b64 v[40:41], 0
    v_max_f32_dpp v3, v3, v3 row_half_mirror row_mask:0xf bank_mask:0xf
    v_mov_b64 v[42:43], 0
    v_mul_f32 v1, v1, v12
    v_max_f32_dpp v3, v3, v3 row_mirror row_mask:0xf bank_mask:0xf
    v_mov_b32 v15, v3
    v_mul_f32 v2, v2, v12
    s_nop 0
    v_permlane16_swap_b32 v3, v15
    v_max_f32 v3, v3, v15
    v_mov_b32 v15, v3
    s_nop 1
    v_permlane32_swap_b32 v3, v15
    v_max_f32 v3, v3, v15
    v_fma_f32 v1, -v3, v12, v1
    v_fma_f32 v2, -v3, v12, v2
    v_exp_f32 v1, v1
    v_exp_f32 v2, v2
    v_mul_f32 v3, v3, v12
    v_cvt_pk_bf16_f32 v15, v1, v2
    ds_write_b32 v54, v15
    ds_read_b128 v[4:7], v52
    ds_read_b128 v[8:11], v55
    ds_read_b128 v[44:47], v52 offset:128
    ds_read_b128 v[48:51], v55 offset:128
    v_add_f32 v1, v1, v2
    buffer_store_dwordx4 v[16:19], v60, s[20:23], s32 offen offset:1024 sc1
    s_cmp_eq_u32 s10, 0
    s_cbranch_scc1 Lx_77
Lr_78:
    s_lshl_b32 s54, s9, 2
    s_add_u32 s54, s54, 158720
    v_add_f32_dpp v1, v1, v1 quad_perm:[1,0,3,2] row_mask:0xf bank_mask:0xf
    v_mov_b32 v2, s54
    v_mov_b32 v52, 158720
    v_add_f32_dpp v1, v1, v1 quad_perm:[2,3,0,1] row_mask:0xf bank_mask:0xf
    ds_write_b32 v2, v3
    s_mul_i32 s54, s9, 768
    v_add_f32_dpp v1, v1, v1 row_half_mirror row_mask:0xf bank_mask:0xf
    s_add_u32 s54, s54, 153600
    v_lshl_add_u32 v54, v0, 2, s54
    v_add_f32_dpp v1, v1, v1 row_mirror row_mask:0xf bank_mask:0xf
    s_waitcnt lgkmcnt(3)
    v_smfmac_f32_16x16x64_bf16 v[20:23], v[4:7], v[64:71], v53
    v_mov_b32 v15, v1
    s_nop 1
    v_permlane16_swap_b32 v1, v15
    v_smfmac_f32_16x16x64_bf16 v[20:23], v[8:11], v[72:79], v53
    v_add_f32 v1, v1, v15
    v_mov_b32 v15, v1
    v_smfmac_f32_16x16x64_bf16 v[24:27], v[4:7], v[80:87], v53
    s_nop 0
    v_permlane32_swap_b32 v1, v15
    v_add_f32 v1, v1, v15
    v_smfmac_f32_16x16x64_bf16 v[24:27], v[8:11], v[88:95], v53
    ds_write_b32 v2, v1 offset:16
    v_smfmac_f32_16x16x64_bf16 v[28:31], v[4:7], v[96:103], v53
    buffer_store_dwordx4 v[16:19], v60, s[20:23], s32 offen offset:2048 sc1
    v_smfmac_f32_16x16x64_bf16 v[28:31], v[8:11], v[104:111], v53
    v_smfmac_f32_16x16x64_bf16 v[32:35], v[4:7], v[112:119], v53
    s_waitcnt lgkmcnt(0)
    v_smfmac_f32_16x16x64_bf16 v[32:35], v[8:11], v[120:127], v53
    s_barrier
    ds_read_b128 v[12:15], v52
    v_smfmac_f32_16x16x64_bf16 v[36:39], v[4:7], v[128:135], v53
    ds_read_b128 v[16:19], v52 offset:16
    s_add_u32 s28, s52, 8192
    v_smfmac_f32_16x16x64_bf16 v[36:39], v[8:11], v[136:143], v53
    s_lshl_b32 s54, s6, 8
    s_add_u32 s29, s28, s54
    v_smfmac_f32_16x16x64_bf16 v[40:43], v[4:7], v[144:151], v53
    s_add_u32 s29, s29, s1
    s_lshl_b32 s54, s6, 5
    v_smfmac_f32_16x16x64_bf16 v[40:43], v[8:11], v[152:159], v53
    s_add_u32 s30, s28, s54
    s_waitcnt lgkmcnt(0)
    s_cmp_eq_u32 s10, 0
    s_cbranch_scc1 Lx_85
Lr_86:
    v_smfmac_f32_16x16x64_bf16 v[20:23], v[44:47], v[160:167], v53
    v_max3_f32 v2, v12, v13, v14
    v_max_f32 v2, v2, v15
    v_smfmac_f32_16x16x64_bf16 v[20:23], v[48:51], v[168:175], v53
    v_sub_f32 v3, v3, v2
    v_sub_f32 v12, v12, v2
    v_smfmac_f32_16x16x64_bf16 v[24:27], v[44:47], v[176:183], v53
    v_exp_f32 v1, v3
    v_smfmac_f32_16x16x64_bf16 v[24:27], v[48:51], v[184:191], v53
    v_sub_f32 v13, v13, v2
    v_sub_f32 v14, v14, v2
    v_smfmac_f32_16x16x64_bf16 v[28:31], v[44:47], v[192:199], v53
    v_sub_f32 v15, v15, v2
    s_xor_b32 s54, s1, 67108864
    v_smfmac_f32_16x16x64_bf16 v[28:31], v[48:51], v[200:207], v53
    v_exp_f32 v12, v12
    v_smfmac_f32_16x16x64_bf16 v[32:35], v[44:47], v[208:215], v53
    v_exp_f32 v13, v13
    v_smfmac_f32_16x16x64_bf16 v[32:35], v[48:51], v[216:223], v53
    v_add_f32_dpp v4, v20, v21 quad_perm:[0,1,2,3] row_mask:0x1 bank_mask:0xf
    v_add_f32_dpp v4, v22, v23 quad_perm:[0,1,2,3] row_mask:0x2 bank_mask:0xf
    v_smfmac_f32_16x16x64_bf16 v[36:39], v[44:47], v[224:231], v53
    v_add_f32_dpp v4, v24, v25 quad_perm:[0,1,2,3] row_mask:0x4 bank_mask:0xf
    v_add_f32_dpp v4, v26, v27 quad_perm:[0,1,2,3] row_mask:0x8 bank_mask:0xf
    v_smfmac_f32_16x16x64_bf16 v[36:39], v[48:51], v[232:239], v53
    v_exp_f32 v14, v14
    v_smfmac_f32_16x16x64_bf16 v[40:43], v[44:47], v[240:247], v53
    v_mul_f32 v4, v4, v1
    ds_write_b32 v54, v4
    v_smfmac_f32_16x16x64_bf16 v[40:43], v[48:51], v[248:255], v53
    v_add_f32_dpp v5, v28, v29 quad_perm:[0,1,2,3] row_mask:0x1 bank_mask:0xf
    v_add_f32_dpp v5, v30, v31 quad_perm:[0,1,2,3] row_mask:0x2 bank_mask:0xf
    v_add_f32_dpp v5, v32, v33 quad_perm:[0,1,2,3] row_mask:0x4 bank_mask:0xf
    v_add_f32_dpp v5, v34, v35 quad_perm:[0,1,2,3] row_mask:0x8 bank_mask:0xf
    v_mul_f32 v5, v5, v1
    ds_write_b32 v54, v5 offset:256
    v_exp_f32 v15, v15
    v_add_f32_dpp v6, v36, v37 quad_perm:[0,1,2,3] row_mask:0x1 bank_mask:0xf
    v_add_f32_dpp v6, v38, v39 quad_perm:[0,1,2,3] row_mask:0x2 bank_mask:0xf
    v_add_f32_dpp v6, v40, v41 quad_perm:[0,1,2,3] row_mask:0x4 bank_mask:0xf
    v_add_f32_dpp v6, v42, v43 quad_perm:[0,1,2,3] row_mask:0x8 bank_mask:0xf
    v_mul_f32 v6, v6, v1
    ds_write_b32 v54, v6 offset:512
    v_mul_f32 v3, v12, v16
    v_fmac_f32 v3, v13, v17
    s_add_u32 s30, s30, s54
    s_lshl_b32 s54, s9, 8
    s_add_u32 s54, s54, 153600
    v_lshl_add_u32 v5, v0, 2, s54
    v_fmac_f32 v3, v14, v18
    v_fmac_f32 v3, v15, v19
    s_waitcnt lgkmcnt(0)
    s_barrier
    ds_read2st64_b32 v[8:9], v5 offset0:0 offset1:3
    ds_read2st64_b32 v[10:11], v5 offset0:6 offset1:9
    v_lshlrev_b32 v26, 2, v0
    v_and_b32 v27, 7, v0
    s_lshl_b32 s54, s9, 11
    s_sub_u32 s54, 6144, s54
    v_lshl_add_u32 v27, v27, 5, s54
    s_cmp_eq_u32 s3, 0
    s_cbranch_scc1 Lx_109
    s_mov_b64 exec, s[40:41]
    buffer_store_dwordx2 v[2:3], v26, s[20:23], s30 offen
    s_mov_b64 exec, -1
    s_waitcnt lgkmcnt(0)
    v_pk_add_f32 v[8:9], v[8:9], v[10:11]
    v_add_f32 v8, v8, v9
    buffer_store_dword v8, v26, s[20:23], s29 offen
Lr_110:
    s_cmp_eq_u32 s10, 0
    s_cbranch_scc1 Lx_111
Lr_112:
    s_cmp_eq_u32 s9, 3
    s_cbranch_scc1 Lx_120
    s_sleep 5
    buffer_load_dwordx2 v[12:13], v27, s[20:23], s28 offen sc1
    buffer_load_dword v4, v26, s[20:23], s28 offen offset:0 sc1
    buffer_load_dword v5, v26, s[20:23], s28 offen offset:256 sc1
    buffer_load_dword v6, v26, s[20:23], s28 offen offset:512 sc1
    buffer_load_dword v7, v26, s[20:23], s28 offen offset:768 sc1
    buffer_load_dword v8, v26, s[20:23], s28 offen offset:1024 sc1
    buffer_load_dword v9, v26, s[20:23], s28 offen offset:1280 sc1
    buffer_load_dword v10, v26, s[20:23], s28 offen offset:1536 sc1
    buffer_load_dword v11, v26, s[20:23], s28 offen offset:1792 sc1
    s_mov_b32 s53, 0
    s_lshl_b32 s54, s9, 7
    s_add_u32 s54, s54, 162304
    v_and_b32 v2, 16, v0
    v_lshrrev_b32 v2, 2, v2
    v_and_b32 v3, 37, v0
    v_lshl_or_b32 v2, v3, 1, v2
    v_and_b32 v3, 8, v0
    v_lshl_or_b32 v2, v3, 2, v2
    v_and_b32 v3, 2, v0
    v_lshl_or_b32 v2, v3, 3, v2
    v_add_u32 v2, s54, v2
    v_lshrrev_b32 v28, 2, v0
    v_mul_u32_u24 v28, 160, v28
    v_and_b32 v29, 3, v0
    v_lshl_add_u32 v28, v29, 3, v28
    s_lshl_b32 s54, s9, 5
    s_add_u32 s54, s54, 0
    v_add_u32 v28, s54, v28
    ds_read_b64_tr_b16 v[30:31], v28 offset:0
    ds_read_b64_tr_b16 v[32:33], v28 offset:2560
    ds_read_b64_tr_b16 v[34:35], v28 offset:5120
    ds_read_b64_tr_b16 v[36:37], v28 offset:7680
    ds_read_b64_tr_b16 v[38:39], v28 offset:10240
    ds_read_b64_tr_b16 v[40:41], v28 offset:12800
    ds_read_b64_tr_b16 v[42:43], v28 offset:15360
    ds_read_b64_tr_b16 v[44:45], v28 offset:17920
    ds_read_b64_tr_b16 v[46:47], v28 offset:20480
    ds_read_b64_tr_b16 v[48:49], v28 offset:23040
    ds_read_b64_tr_b16 v[50:51], v28 offset:25600
    ds_read_b64_tr_b16 v[52:53], v28 offset:28160
    v_and_b32 v29, 1, v0
    v_lshlrev_b32 v29, 4, v29
    v_lshrrev_b32 v55, 4, v0
    v_lshl_add_u32 v55, v55, 5, v29
    v_add_u32 v55, 162304, v55
    v_and_b32 v29, 1, v0
    v_mul_u32_u24 v29, 0xaaaa, v29
    v_or_b32 v29, 0x4444, v29
    v_mov_b64 v[22:23], 0
    s_cmp_eq_u32 s10, 0
    s_cbranch_scc1 Lx_125
    s_waitcnt vmcnt(8)
    v_max_f32_dpp v14, v12, v12 quad_perm:[1,0,3,2] row_mask:0xf bank_mask:0xf
    s_nop 1
    v_max_f32_dpp v14, v14, v14 quad_perm:[2,3,0,1] row_mask:0xf bank_mask:0xf
    s_nop 1
    v_max_f32_dpp v14, v14, v14 row_half_mirror row_mask:0xf bank_mask:0xf
    v_sub_f32 v12, v12, v14
    v_exp_f32 v12, v12
    s_nop 0
    v_mul_f32 v13, v13, v12
    s_waitcnt vmcnt(0)
Lc2_126:
    v_mul_f32_dpp v4, v12, v4 row_newbcast:0 row_mask:0xf bank_mask:0xf
    v_mul_f32_dpp v5, v12, v5 row_newbcast:1 row_mask:0xf bank_mask:0xf
    v_add_f32_dpp v13, v13, v13 quad_perm:[1,0,3,2] row_mask:0xf bank_mask:0xf
    v_fmac_f32_dpp v4, v12, v6 row_newbcast:2 row_mask:0xf bank_mask:0xf
    v_fmac_f32_dpp v5, v12, v7 row_newbcast:3 row_mask:0xf bank_mask:0xf
    v_add_f32_dpp v13, v13, v13 quad_perm:[2,3,0,1] row_mask:0xf bank_mask:0xf
    v_fmac_f32_dpp v4, v12, v8 row_newbcast:4 row_mask:0xf bank_mask:0xf
    v_fmac_f32_dpp v5, v12, v9 row_newbcast:5 row_mask:0xf bank_mask:0xf
    v_add_f32_dpp v13, v13, v13 row_half_mirror row_mask:0xf bank_mask:0xf
    v_fmac_f32_dpp v4, v12, v10 row_newbcast:6 row_mask:0xf bank_mask:0xf
    v_fmac_f32_dpp v5, v12, v11 row_newbcast:7 row_mask:0xf bank_mask:0xf
    v_rcp_f32 v13, v13
    v_add_f32 v4, v4, v5
    v_mul_f32 v4, v4, v13
    v_cvt_pk_bf16_f32 v5, v4, v4
    ds_write_b16 v2, v5
    v_cmp_u_f32 vcc, v4, v4
    s_cbranch_vccnz Lcold_124
Lok_123:
    s_waitcnt lgkmcnt(0)
    s_barrier
    ds_read_b128 v[4:7], v55
    ds_read_b128 v[8:11], v55 offset:128
    ds_read_b128 v[12:15], v55 offset:256
    s_cmp_eq_u32 s10, 0
    s_cbranch_scc1 Lx_130
Lr_131:
    s_cmp_lt_u32 s9, 2
    s_cselect_b32 s55, 63, 59
    s_min_u32 s54, s9, 2
    s_lshl_b32 s54, s54, 3
    v_and_b32 v54, s55, v0
    v_and_b32 v60, 7, v54
    v_lshlrev_b32 v54, 4, v54
    v_add_u32 v60, s54, v60
    s_waitcnt lgkmcnt(2)
    v_smfmac_f32_16x16x64_bf16 v[22:25], v[4:7], v[30:37], v29
    s_waitcnt lgkmcnt(1)
    v_smfmac_f32_16x16x64_bf16 v[22:25], v[8:11], v[38:45], v29
    s_waitcnt lgkmcnt(0)
    v_smfmac_f32_16x16x64_bf16 v[22:25], v[12:15], v[46:53], v29
    s_mov_b64 exec, s[38:39]
    s_nop 6
    v_add_f32 v22, v22, v23
    buffer_store_dword v22, v26, s[20:23], s45 offen sc1
    s_mov_b64 exec, -1
Lr_121:
    s_cmp_eq_u32 s10, 0
    s_cbranch_scc1 Lx_140
Lr_141:
    v_and_b32 v3, 1, v0
    v_lshlrev_b32 v3, 4, v3
    v_lshrrev_b32 v1, 4, v0
    v_lshl_add_u32 v1, v1, 5, v3
    v_and_b32 v3, 2, v0
    v_mul_u32_u24 v3, 96, v3
    v_add_u32 v3, 161792, v3
    v_add_u32 v1, v1, v3
    v_lshrrev_b32 v2, 4, v0
    v_lshl_add_u32 v2, v2, 3, v3
    v_add_u32 v2, 128, v2
    v_and_b32 v3, 1, v0
    v_cmp_eq_u32 vcc, 1, v3
    v_mov_b32 v3, 162144
    s_nop 0
    v_cndmask_b32 v2, v2, v3, vcc
    v_and_b32 v4, 1, v0
    v_mul_u32_u24 v4, 0xaaaa, v4
    v_or_b32 v4, 0x4444, v4
    s_mul_i32 s54, s9, 48
    v_add_u32 v5, s54, v0
    v_lshrrev_b32 v3, 6, v5
    v_mul_u32_u24 v3, 448, v3
    s_lshl_b32 s55, s6, 8
    s_lshl_b32 s56, s9, 11
    s_sub_u32 s55, s55, s56
    s_add_u32 s55, s55, 8192
    v_add_lshl_u32 v5, v5, v3, 2
    v_add_u32 v5, s55, v5
    s_add_u32 s32, s52, 8192
    s_mul_i32 s33, s9, 4294965252
    s_lshl_b32 s55, s6, 5
    s_add_u32 s33, s33, s55
    s_add_u32 s33, s33, s52
    s_add_u32 s33, s33, 22528
    s_add_u32 s33, s33, s1
    v_bfe_u32 v7, v0, 2, 3
    v_and_b32 v6, 6, v7
    v_lshlrev_b32 v7, 7, v7
    v_lshl_add_u32 v7, v6, 4, v7
    v_and_b32 v6, 3, v0
    v_lshl_add_u32 v7, v6, 3, v7
    v_lshrrev_b32 v6, 5, v0
    v_mul_u32_u24 v6, 3072, v6
    v_add_u32 v7, v7, v6
    s_mul_i32 s54, s9, 3
    s_add_u32 s54, s54, 0
    s_and_b32 s55, s54, 3
    s_lshl_b32 s55, s55, 5
    s_lshr_b32 s56, s54, 2
    s_lshl_b32 s56, s56, 10
    s_add_u32 s56, s56, 30720
    v_xor_b32 v6, s55, v7
    v_add_u32 v6, s56, v6
    ds_read_b64_tr_b16 v[24:25], v6 offset:0
    ds_read_b64_tr_b16 v[26:27], v6 offset:6144
    ds_read_b64_tr_b16 v[28:29], v6 offset:12288
    ds_read_b64_tr_b16 v[30:31], v6 offset:18432
    ds_read_b64_tr_b16 v[32:33], v6 offset:24576
    s_mul_i32 s54, s9, 3
    s_add_u32 s54, s54, 1
    s_and_b32 s55, s54, 3
    s_lshl_b32 s55, s55, 5
    s_lshr_b32 s56, s54, 2
    s_lshl_b32 s56, s56, 10
    s_add_u32 s56, s56, 30720
    v_xor_b32 v6, s55, v7
    v_add_u32 v6, s56, v6
    ds_read_b64_tr_b16 v[34:35], v6 offset:0
    ds_read_b64_tr_b16 v[36:37], v6 offset:6144
    ds_read_b64_tr_b16 v[38:39], v6 offset:12288
    ds_read_b64_tr_b16 v[40:41], v6 offset:18432
    ds_read_b64_tr_b16 v[42:43], v6 offset:24576
    s_mul_i32 s54, s9, 3
    s_add_u32 s54, s54, 2
    s_and_b32 s55, s54, 3
    s_lshl_b32 s55, s55, 5
    s_lshr_b32 s56, s54, 2
    s_lshl_b32 s56, s56, 10
    s_add_u32 s56, s56, 30720
    v_xor_b32 v6, s55, v7
    v_add_u32 v6, s56, v6
    ds_read_b64_tr_b16 v[44:45], v6 offset:0
    ds_read_b64_tr_b16 v[46:47], v6 offset:6144
    ds_read_b64_tr_b16 v[48:49], v6 offset:12288
    ds_read_b64_tr_b16 v[50:51], v6 offset:18432
    ds_read_b64_tr_b16 v[52:53], v6 offset:24576
    s_cmp_eq_u32 s9, 3
    s_cbranch_scc1 Lx_148
    v_lshrrev_b32 v55, 4, v0
    v_lshl_add_u32 v60, v60, 2, v55
    v_and_b32 v55, 16, v60
    v_lshrrev_b32 v55, 2, v55
    v_and_b32 v3, 37, v60
    v_lshl_or_b32 v55, v3, 1, v55
    v_and_b32 v3, 8, v60
    v_lshl_or_b32 v55, v3, 2, v55
    v_and_b32 v3, 2, v60
    v_lshl_or_b32 v55, v3, 3, v55
    v_cmp_gt_u32 vcc, 64, v60
    v_lshlrev_b32 v60, 1, v60
    s_nop 0
    v_cndmask_b32 v55, v60, v55, vcc
    v_add_u32 v55, 161792, v55
    ds_read_u16 v22, v55
    s_sleep 8
    buffer_load_dwordx4 v[6:9], v54, s[20:23], s46 offen offset:0 sc1
    buffer_load_dwordx4 v[10:13], v54, s[20:23], s46 offen offset:1024 sc1
    buffer_load_dwordx4 v[14:17], v54, s[20:23], s46 offen offset:2048 sc1
    buffer_load_dwordx4 v[18:21], v54, s[20:23], s46 offen offset:3072 sc1
    s_mov_b32 s53, 0
    s_waitcnt lgkmcnt(0)
    v_lshlrev_b32 v22, 16, v22
    s_cmp_eq_u32 s10, 0
    s_cbranch_scc1 Lx_153
    s_waitcnt vmcnt(0)
Lc_150:
    v_pk_add_f32 v[6:7], v[6:7], v[10:11]
    v_pk_add_f32 v[14:15], v[14:15], v[18:19]
    v_pk_add_f32 v[8:9], v[8:9], v[12:13]
    v_pk_add_f32 v[6:7], v[6:7], v[14:15]
    v_pk_add_f32 v[16:17], v[16:17], v[20:21]
    v_pk_add_f32 v[8:9], v[8:9], v[16:17]
    v_permlane16_swap_b32 v6, v7
    v_add_f32 v6, v6, v7
    v_permlane16_swap_b32 v8, v9
    v_add_f32 v8, v8, v9
    s_nop 1
    v_permlane32_swap_b32 v6, v8
    v_add_f32 v6, v6, v8
    s_nop 1
    v_add_f32_dpp v6, v6, v6 row_ror:8 row_mask:0xf bank_mask:0xf
    v_cvt_pk_bf16_f32 v7, v6, v6
    v_lshlrev_b32 v7, 16, v7
    v_add_f32 v7, v7, v22
    v_cvt_pk_bf16_f32 v20, v7, v7
    ds_write_b16 v55, v20
    v_cmp_u_f32 vcc, v6, v6
    s_cbranch_vccnz Lcold_152
Lok_151:
    v_lshlrev_b32 v3, 16, v20
    v_cndmask_b32 v3, 0, v3, s[58:59]
    s_nop 1
    v_mul_f32_dpp v3, v3, v3 quad_perm:[0,1,2,3] row_mask:0xf bank_mask:0x3
Lr_149:
    s_waitcnt lgkmcnt(0)
    s_barrier
    ds_read_b64 v[10:11], v2
    ds_read_b128 v[6:9], v1
    v_add_f32_dpp v3, v3, v3 quad_perm:[1,0,3,2] row_mask:0xf bank_mask:0xf
    v_lshlrev_b32 v54, 2, v0
    v_and_b32 v55, 7, v0
    v_add_f32_dpp v3, v3, v3 quad_perm:[2,3,0,1] row_mask:0xf bank_mask:0xf
    s_lshl_b32 s54, s9, 11
    s_sub_u32 s54, 6144, s54
    v_add_f32_dpp v3, v3, v3 row_half_mirror row_mask:0xf bank_mask:0xf
    v_lshl_add_u32 v55, v55, 5, s54
    v_mov_b32 v2, v3
    s_waitcnt lgkmcnt(1)
    v_mfma_f32_16x16x16_bf16 v[12:15], v[10:11], v[32:33], 0
    v_permlane16_swap_b32 v3, v2
    v_add_f32 v3, v3, v2
    v_mfma_f32_16x16x16_bf16 v[16:19], v[10:11], v[42:43], 0
    v_mov_b32 v2, v3
    v_and_b32 v1, 8, v0
    v_mfma_f32_16x16x16_bf16 v[20:23], v[10:11], v[52:53], 0
    v_permlane32_swap_b32 v3, v2
    v_add_f32 v3, v3, v2
    s_waitcnt lgkmcnt(0)
    v_smfmac_f32_16x16x64_bf16 v[12:15], v[6:9], v[24:31], v4
    v_lshlrev_b32 v1, 1, v1
    v_sub_u32 v1, 16, v1
    v_smfmac_f32_16x16x64_bf16 v[16:19], v[6:9], v[34:41], v4
    s_add_u32 s28, s32, 8192
    s_add_u32 s45, s45, 98304
    v_smfmac_f32_16x16x64_bf16 v[20:23], v[6:9], v[44:51], v4
    s_add_u32 s46, s46, 98304
    s_cmp_eq_u32 s3, 0
    s_cbranch_scc1 Lx_160
    s_mov_b64 exec, 0x101
    buffer_store_dword v3, v1, s[20:23], s33 offen
    s_mov_b64 exec, s[36:37]
    v_add_f32_dpp v2, v12, v13 quad_perm:[0,1,2,3] row_mask:0x1 bank_mask:0xf
    v_add_f32_dpp v2, v16, v17 quad_perm:[0,1,2,3] row_mask:0x2 bank_mask:0xf
    v_add_f32_dpp v2, v20, v21 quad_perm:[0,1,2,3] row_mask:0x4 bank_mask:0xf
    buffer_store_dword v2, v5, s[20:23], s32 offen
    s_mov_b64 exec, -1
Lr_161:
    s_cmp_eq_u32 s10, 0
    s_cbranch_scc1 Lx_162
Lr_163:
    s_cmp_eq_u32 s9, 3
    s_cbranch_scc1 Lx_166
    s_sleep 4
    buffer_load_dwordx3 v[12:14], v55, s[20:23], s28 offen sc1
    buffer_load_dwordx3 v[16:18], v55, s[20:23], s28 offen offset:16 sc1
    buffer_load_dword v4, v54, s[20:23], s28 offen offset:0 sc1
    buffer_load_dword v5, v54, s[20:23], s28 offen offset:256 sc1
    buffer_load_dword v6, v54, s[20:23], s28 offen offset:512 sc1
    buffer_load_dword v7, v54, s[20:23], s28 offen offset:768 sc1
    buffer_load_dword v8, v54, s[20:23], s28 offen offset:1024 sc1
    buffer_load_dword v9, v54, s[20:23], s28 offen offset:1280 sc1
    buffer_load_dword v10, v54, s[20:23], s28 offen offset:1536 sc1
    buffer_load_dword v11, v54, s[20:23], s28 offen offset:1792 sc1
    s_mov_b32 s53, 0
    s_lshl_b32 s54, s9, 7
    s_add_u32 s54, s54, 162304
    v_and_b32 v2, 12, v0
    v_and_b32 v3, 49, v0
    v_lshl_or_b32 v2, v3, 1, v2
    v_and_b32 v3, 2, v0
    v_lshl_or_b32 v2, v3, 3, v2
    v_add_u32 v2, s54, v2
    v_and_b32 v53, 1, v0
    v_lshlrev_b32 v53, 4, v53
    v_lshrrev_b32 v52, 4, v0
    v_lshl_add_u32 v52, v52, 5, v53
    v_add_u32 v52, 162304, v52
    v_and_b32 v53, 1, v0
    v_mul_u32_u24 v53, 0xaaaa, v53
    v_or_b32 v53, 0x4444, v53
    v_lshlrev_b32 v50, 1, v0
    v_mov_b64 v[40:41], 0
    v_mov_b64 v[44:45], 0
    s_cmp_eq_u32 s10, 0
    s_cbranch_scc1 Lx_171
Lr_172:
    s_cmp_eq_u32 s10, 0
    s_cbranch_scc1 Lx_174
    s_waitcnt vmcnt(8)
    v_add_f32 v12, v12, v13
    v_add_f32 v12, v12, v14
    v_add_f32 v16, v16, v17
    v_add_f32 v16, v16, v18
    v_add_f32_dpp v12, v12, v12 quad_perm:[1,0,3,2] row_mask:0xf bank_mask:0xf
    s_nop 1
    v_add_f32_dpp v12, v12, v12 quad_perm:[2,3,0,1] row_mask:0xf bank_mask:0xf
    s_nop 1
    v_add_f32_dpp v12, v12, v12 row_half_mirror row_mask:0xf bank_mask:0xf
    s_waitcnt vmcnt(0)
Lc2_175:
    v_pk_add_f32 v[4:5], v[4:5], v[6:7]
    v_pk_add_f32 v[8:9], v[8:9], v[10:11]
    v_pk_add_f32 v[4:5], v[4:5], v[8:9]
    v_add_f32 v4, v4, v5
    v_fma_f32 v4, -v12, v62, v4
    v_cvt_pk_bf16_f32 v5, v4, v4
    ds_write_b16 v2, v5
    v_cmp_u_f32 vcc, v4, v16
    s_cbranch_vccnz Lcold_170
Lok_169:
Lr_167:
    s_waitcnt lgkmcnt(0)
    s_barrier
    ds_read_b128 v[28:31], v52
    ds_read_b128 v[32:35], v52 offset:128
    ds_read_b128 v[36:39], v52 offset:256
    v_add_f32_dpp v16, v16, v16 quad_perm:[1,0,3,2] row_mask:0xf bank_mask:0xf
    v_mul_f32 v12, 986500301, v12
    v_mov_b32 v13, 162880
    v_add_f32_dpp v16, v16, v16 quad_perm:[2,3,0,1] row_mask:0xf bank_mask:0xf
    v_mul_f32 v12, v12, v12
    s_min_u32 s54, s9, 1
    v_add_f32_dpp v16, v16, v16 row_half_mirror row_mask:0xf bank_mask:0xf
    s_lshl_b32 s54, s54, 5
    s_waitcnt lgkmcnt(2)
    v_smfmac_f32_16x16x64_bf16 v[40:43], v[28:31], a[192:199], v53
    v_smfmac_f32_16x16x64_bf16 v[44:47], v[28:31], a[216:223], v53
    s_waitcnt lgkmcnt(1)
    v_smfmac_f32_16x16x64_bf16 v[40:43], v[32:35], a[200:207], v53
    v_smfmac_f32_16x16x64_bf16 v[44:47], v[32:35], a[224:231], v53
    s_waitcnt lgkmcnt(0)
    v_smfmac_f32_16x16x64_bf16 v[40:43], v[36:39], a[208:215], v53
    v_smfmac_f32_16x16x64_bf16 v[44:47], v[36:39], a[232:239], v53
    v_mul_f32 v16, 986500301, v16
    v_sub_f32 v16, v16, v12
    v_max_f32 v16, 0, v16
    v_add_f32 v16, 925353388, v16
    v_rsq_f32 v16, v16
    v_add_u32 v13, s54, v13
    s_nop 0
    v_add_f32_dpp v48, v40, v41 quad_perm:[0,1,2,3] row_mask:0x1 bank_mask:0xf
    v_add_f32_dpp v48, v44, v45 quad_perm:[0,1,2,3] row_mask:0x2 bank_mask:0xf
    v_mul_f32 v16, s44, v16
    ds_write_b32 v13, v16
    v_mov_b32_dpp v49, v48 quad_perm:[1,1,3,3] row_mask:0xf bank_mask:0xf
    s_mov_b64 exec, s[92:93]
    v_cvt_pk_bf16_f32 v48, v48, v49
    buffer_store_dword v48, v50, s[20:23], s63 offen sc1
    s_mov_b64 exec, -1
    s_cmp_eq_u32 s10, 0
    s_cbranch_scc1 Lx_188
Lr_189:
    s_lshr_b32 s54, s9, 1
    s_mul_i32 s54, s54, 12288
    s_add_u32 s54, s54, 129024
    v_and_b32 v1, 7, v0
    v_and_b32 v3, 6, v0
    v_lshrrev_b32 v2, 4, v0
    v_xor_b32 v3, v3, v2
    v_lshlrev_b32 v1, 7, v1
    v_lshl_add_u32 v1, v3, 4, v1
    v_bfe_u32 v3, v0, 3, 1
    v_mul_u32_u24 v3, 3072, v3
    v_add3_u32 v1, v1, v3, s54
    v_xor_b32 v3, 64, v1
    s_waitcnt lgkmcnt(0)
    s_barrier
    v_and_b32 v60, 15, v0
    v_lshlrev_b32 v60, 6, v60
    v_lshl_add_u32 v2, v2, 4, v60
    s_add_u32 s28, s94, 4096
    s_xor_b32 s29, s95, 8192
    s_xor_b32 s30, s95, 16384
    s_xor_b32 s31, s95, 24576
    ds_read_b128 v[28:31], v1 offset:0
    ds_read_b128 v[32:35], v3 offset:0
    ds_read_b128 v[36:39], v1 offset:1024
    ds_read_b128 v[40:43], v3 offset:1024
    ds_read_b128 v[44:47], v1 offset:2048
    v_lshlrev_b32 v60, 4, v0
    s_sleep 10
    buffer_load_dwordx4 v[4:7], v2, s[20:23], s94 offen offset:0 sc1
    buffer_load_dwordx4 v[8:11], v2, s[20:23], s94 offen offset:1024 sc1
    buffer_load_dwordx4 v[12:15], v2, s[20:23], s94 offen offset:2048 sc1
    buffer_load_dwordx4 v[16:19], v2, s[20:23], s94 offen offset:3072 sc1
    buffer_load_dwordx4 v[20:23], v2, s[20:23], s28 offen offset:0 sc1
    buffer_load_dwordx4 v[24:27], v2, s[20:23], s28 offen offset:1024 sc1
    s_mov_b32 s53, 0
    s_waitcnt vmcnt(0)
Lc_190:
    s_waitcnt lgkmcnt(4)
    v_mfma_f32_16x16x32_bf16 v[52:55], v[28:31], v[4:7], 0
    ds_read_b128 v[28:31], v3 offset:2048
    s_waitcnt lgkmcnt(4)
    v_mfma_f32_16x16x32_bf16 v[52:55], v[32:35], v[8:11], v[52:55]
    ds_read_b128 v[32:35], v1 offset:6144
    s_waitcnt lgkmcnt(4)
    v_mfma_f32_16x16x32_bf16 v[52:55], v[36:39], v[12:15], v[52:55]
    ds_read_b128 v[36:39], v3 offset:6144
    s_waitcnt lgkmcnt(4)
    v_mfma_f32_16x16x32_bf16 v[52:55], v[40:43], v[16:19], v[52:55]
    ds_read_b128 v[40:43], v1 offset:7168
    s_waitcnt lgkmcnt(4)
    v_mfma_f32_16x16x32_bf16 v[52:55], v[44:47], v[20:23], v[52:55]
    ds_read_b128 v[44:47], v3 offset:7168
    s_waitcnt lgkmcnt(4)
    v_mfma_f32_16x16x32_bf16 v[52:55], v[28:31], v[24:27], v[52:55]
    ds_read_b128 v[28:31], v1 offset:8192
    s_waitcnt lgkmcnt(4)
    v_mfma_f32_16x16x32_bf16 v[48:51], v[32:35], v[4:7], 0
    ds_read_b128 v[32:35], v3 offset:8192
    s_waitcnt lgkmcnt(4)
    v_mfma_f32_16x16x32_bf16 v[48:51], v[36:39], v[8:11], v[48:51]
    s_waitcnt lgkmcnt(3)
    v_mfma_f32_16x16x32_bf16 v[48:51], v[40:43], v[12:15], v[48:51]
    s_waitcnt lgkmcnt(2)
    v_mfma_f32_16x16x32_bf16 v[48:51], v[44:47], v[16:19], v[48:51]
    v_cmp_u_f32 vcc, v52, v52
    s_nop 3
    s_cbranch_vccnz Lcold_192
Lok_191:
    s_cmp_eq_u32 s3, 0
    s_waitcnt lgkmcnt(1)
    v_mfma_f32_16x16x32_bf16 v[48:51], v[28:31], v[20:23], v[48:51]
    s_waitcnt lgkmcnt(0)
    v_mfma_f32_16x16x32_bf16 v[48:51], v[32:35], v[24:27], v[48:51]
    s_nop 5
    s_cbranch_scc1 Lx_196
    buffer_store_dwordx4 v[52:55], v60, s[20:23], s95 offen
    buffer_store_dwordx4 v[48:51], v60, s[20:23], s95 offen offset:1024
Lr_197:
    s_sleep 7
    buffer_load_dwordx4 v[4:7], v60, s[20:23], s29 offen sc1
    buffer_load_dwordx4 v[8:11], v60, s[20:23], s29 offen offset:1024 sc1
    buffer_load_dwordx4 v[12:15], v60, s[20:23], s30 offen sc1
    buffer_load_dwordx4 v[16:19], v60, s[20:23], s30 offen offset:1024 sc1
    buffer_load_dwordx4 v[20:23], v60, s[20:23], s31 offen sc1
    buffer_load_dwordx4 v[24:27], v60, s[20:23], s31 offen offset:1024 sc1
    s_mov_b32 s53, 0
    v_bfe_u32 v1, v0, 2, 3
    v_and_b32 v3, 6, v1
    v_lshlrev_b32 v1, 7, v1
    v_lshl_add_u32 v1, v3, 4, v1
    v_and_b32 v3, 3, v0
    v_lshlrev_b32 v3, 4, v3
    v_xor_b32 v1, v1, v3
    v_lshrrev_b32 v3, 5, v0
    v_mul_u32_u24 v3, 3072, v3
    v_add_u32 v1, v1, v3
    s_lshr_b32 s32, s9, 1
    s_mul_i32 s54, s32, 13312
    s_add_u32 s54, s54, 129024
    s_lshl_b32 s55, s32, 6
    s_lshl_b32 s56, s32, 10
    v_xor_b32 v1, s55, v1
    v_add_u32 v1, s54, v1
    v_xor_b32 v2, 64, v1
    v_add_u32 v2, s56, v2
    v_mov_b32 v3, 162880
    ds_read_b32 v3, v3
    ds_read_b64_tr_b16 v[28:29], v1 offset:0
    ds_read_b64_tr_b16 v[30:31], v1 offset:6144
    ds_read_b64_tr_b16 v[32:33], v1 offset:8
    ds_read_b64_tr_b16 v[34:35], v1 offset:6152
    ds_read_b64_tr_b16 v[36:37], v2 offset:0
    ds_read_b64_tr_b16 v[38:39], v2 offset:6144
    ds_read_b64_tr_b16 v[40:41], v2 offset:8
    ds_read_b64_tr_b16 v[42:43], v2 offset:6152
    ds_read_b64_tr_b16 v[44:45], v1 offset:1024
    ds_read_b64_tr_b16 v[46:47], v1 offset:7168
    s_mul_i32 s33, s32, 4294942720
    s_add_u32 s33, s33, 12288
    s_lshl_b32 s34, s9, 11
    s_xor_b32 s35, s34, 4096
    s_add_u32 s34, s34, 153600
    s_add_u32 s35, s35, 153600
    s_waitcnt lgkmcnt(10)
    v_readfirstlane_b32 s32, v3
    s_waitcnt vmcnt(0)
Lc_198:
    v_pk_add_f32 v[4:5], v[4:5], v[52:53]
    v_pk_add_f32 v[6:7], v[6:7], v[54:55]
    v_pk_add_f32 v[12:13], v[12:13], v[20:21]
    v_pk_add_f32 v[14:15], v[14:15], v[22:23]
    v_pk_add_f32 v[8:9], v[8:9], v[48:49]
    v_pk_add_f32 v[10:11], v[10:11], v[50:51]
    v_pk_add_f32 v[16:17], v[16:17], v[24:25]
    v_pk_add_f32 v[18:19], v[18:19], v[26:27]
    v_pk_add_f32 v[4:5], v[4:5], v[12:13]
    v_pk_add_f32 v[6:7], v[6:7], v[14:15]
    v_pk_add_f32 v[8:9], v[8:9], v[16:17]
    v_pk_add_f32 v[10:11], v[10:11], v[18:19]
    v_max3_f32 v12, v4, v5, v6
    v_max3_f32 v13, v7, v8, v9
    v_max3_f32 v12, v12, v10, v11
    v_max_f32 v12, v12, v13
    v_mov_b32 v13, v12
    v_pk_add_f32 v[14:15], v[4:5], v[6:7]
    v_pk_add_f32 v[16:17], v[8:9], v[10:11]
    v_permlane16_swap_b32 v12, v13
    v_max_f32 v12, v12, v13
    v_mov_b32 v13, v12
    v_pk_add_f32 v[14:15], v[14:15], v[16:17]
    v_cmp_u_f32 vcc, v14, v15
    s_cbranch_vccnz Lcold_200
Lok_199:
    v_permlane32_swap_b32 v12, v13
    v_max_f32 v12, v12, v13
    v_mul_f32_e64 v14, -v12, s32
    v_mov_b32 v16, s32
    v_floor_f32 v14, v14
    ds_read_b64_tr_b16 v[48:49], v1 offset:1032
    ds_read_b64_tr_b16 v[50:51], v1 offset:7176
    v_pk_fma_f32 v[4:5], v[4:5], v[16:17], v[14:15] op_sel_hi:[1,0,0]
    v_pk_fma_f32 v[6:7], v[6:7], v[16:17], v[14:15] op_sel_hi:[1,0,0]
    v_pk_fma_f32 v[8:9], v[8:9], v[16:17], v[14:15] op_sel_hi:[1,0,0]
    v_pk_fma_f32 v[10:11], v[10:11], v[16:17], v[14:15] op_sel_hi:[1,0,0]
    v_add_u32 v1, s33, v1
    v_add_u32 v2, s33, v2
    v_exp_f32 v4, v4
    v_exp_f32 v5, v5
    v_exp_f32 v6, v6
    v_exp_f32 v7, v7
    v_exp_f32 v8, v8
    v_exp_f32 v9, v9
    v_exp_f32 v10, v10
    v_exp_f32 v11, v11
    v_add_u32 v3, s34, v60
    v_cvt_pk_bf16_f32 v16, v4, v5
    v_cvt_pk_bf16_f32 v17, v6, v7
    v_cvt_pk_bf16_f32 v18, v8, v9
    v_cvt_pk_bf16_f32 v19, v10, v11
    ds_write_b128 v3, v[16:19]
    v_pk_add_f32 v[4:5], v[4:5], v[6:7]
    v_pk_add_f32 v[8:9], v[8:9], v[10:11]
    v_pk_add_f32 v[4:5], v[4:5], v[8:9]
    v_add_f32 v15, v4, v5
    ds_write_b64 v3, v[14:15] offset:1024
    v_add_u32 v3, s35, v60
    ds_read_b64_tr_b16 v[52:53], v1 offset:0
    ds_read_b64_tr_b16 v[54:55], v1 offset:6144
    ds_read_b64_tr_b16 v[20:21], v1 offset:8
    ds_read_b64_tr_b16 v[22:23], v1 offset:6152
    ds_read_b64_tr_b16 v[24:25], v2 offset:0
    ds_read_b64_tr_b16 v[26:27], v2 offset:6144
    s_waitcnt lgkmcnt(6)
    s_barrier
    ds_read_b64 v[12:13], v3 offset:1024
    ds_read_b128 v[8:11], v3
    ds_read_b64_tr_b16 v[4:5], v2 offset:8
    ds_read_b64_tr_b16 v[6:7], v2 offset:6152
    v_bfe_u32 v60, v0, 1, 3
    v_mul_u32_u24 v60, 196608, v60
    v_and_b32 v3, 1, v0
    v_lshl_add_u32 v60, v3, 6, v60
    v_and_b32 v3, 48, v0
    v_add_u32 v60, v60, v3
    s_waitcnt lgkmcnt(3)
    v_min_f32 v2, v14, v12
    v_sub_f32 v14, v14, v2
    v_sub_f32 v12, v12, v2
    v_min_f32 v14, 0x437f0000, v14
    v_min_f32 v12, 0x437f0000, v12
    v_cvt_u32_f32 v3, v14
    v_mul_u32_u24 v3, 0x800080, v3
    v_pk_sub_u16 v16, v16, v3 clamp
    v_pk_sub_u16 v17, v17, v3 clamp
    v_pk_sub_u16 v18, v18, v3 clamp
    v_pk_sub_u16 v19, v19, v3 clamp
    v_cvt_u32_f32 v3, v12
    v_mul_u32_u24 v3, 0x800080, v3
    v_mfma_f32_16x16x32_bf16 v[28:31], v[28:31], v[16:19], 0
    s_waitcnt lgkmcnt(2)
    v_pk_sub_u16 v8, v8, v3 clamp
    v_pk_sub_u16 v9, v9, v3 clamp
    v_mfma_f32_16x16x32_bf16 v[32:35], v[32:35], v[16:19], 0
    v_pk_sub_u16 v10, v10, v3 clamp
    v_pk_sub_u16 v11, v11, v3 clamp
    v_mfma_f32_16x16x32_bf16 v[36:39], v[36:39], v[16:19], 0
    v_exp_f32_e64 v14, -v14
    v_mfma_f32_16x16x32_bf16 v[28:31], v[52:55], v[8:11], v[28:31]
    ds_read_b64_tr_b16 v[52:53], v1 offset:1024
    ds_read_b64_tr_b16 v[54:55], v1 offset:7168
    v_mfma_f32_16x16x32_bf16 v[32:35], v[20:23], v[8:11], v[32:35]
    ds_read_b64_tr_b16 v[20:21], v1 offset:1032
    ds_read_b64_tr_b16 v[22:23], v1 offset:7176
    v_mfma_f32_16x16x32_bf16 v[40:43], v[40:43], v[16:19], 0
    v_exp_f32_e64 v12, -v12
    v_mfma_f32_16x16x32_bf16 v[36:39], v[24:27], v[8:11], v[36:39]
    v_mul_f32 v3, v15, v14
    s_waitcnt lgkmcnt(4)
    v_mfma_f32_16x16x32_bf16 v[40:43], v[4:7], v[8:11], v[40:43]
    v_fmac_f32 v3, v13, v12
    v_sub_f32 v2, 0, v2
    v_mfma_f32_16x16x32_bf16 v[44:47], v[44:47], v[16:19], 0
    v_mov_b32 v1, v3
    v_cvt_pk_bf16_f32 v24, v28, v29
    v_mfma_f32_16x16x32_bf16 v[48:51], v[48:51], v[16:19], 0
    v_cvt_pk_bf16_f32 v25, v30, v31
    v_permlane16_swap_b32 v3, v1
    s_waitcnt lgkmcnt(2)
    v_mfma_f32_16x16x32_bf16 v[44:47], v[52:55], v[8:11], v[44:47]
    v_cvt_pk_bf16_f32 v26, v32, v33
    v_cvt_pk_bf16_f32 v27, v34, v35
    s_waitcnt lgkmcnt(0)
    v_mfma_f32_16x16x32_bf16 v[48:51], v[20:23], v[8:11], v[48:51]
    buffer_store_dwordx4 v[24:27], v60, s[20:23], s98 offen offset:0 sc1
    v_add_f32 v3, v3, v1
    v_mov_b32 v1, v3
    v_cvt_pk_bf16_f32 v4, v36, v37
    v_cvt_pk_bf16_f32 v5, v38, v39
    v_permlane32_swap_b32 v3, v1
    v_cvt_pk_bf16_f32 v6, v40, v41
    v_cvt_pk_bf16_f32 v7, v42, v43
    buffer_store_dwordx4 v[4:7], v60, s[20:23], s98 offen offset:128 sc1
    v_add_f32 v3, v3, v1
    v_lshlrev_b32 v1, 3, v0
    s_mov_b64 exec, s[38:39]
    buffer_store_dwordx2 v[2:3], v1, s[20:23], s100 offen sc1
    s_mov_b64 exec, -1
    v_cvt_pk_bf16_f32 v8, v44, v45
    v_cvt_pk_bf16_f32 v9, v46, v47
    v_cvt_pk_bf16_f32 v10, v48, v49
    v_cvt_pk_bf16_f32 v11, v50, v51
    buffer_store_dwordx4 v[8:11], v60, s[20:23], s98 offen offset:256 sc1
    v_bfe_u32 v55, v0, 2, 3
    v_and_b32 v54, 6, v55
    v_lshlrev_b32 v55, 7, v55
    v_lshl_add_u32 v55, v54, 4, v55
    v_and_b32 v54, 3, v0
    v_lshl_add_u32 v55, v54, 3, v55
    v_lshrrev_b32 v54, 5, v0
    v_mul_u32_u24 v54, 3072, v54
    v_add_u32 v55, v55, v54
    s_mul_i32 s54, s9, 3
    s_add_u32 s54, s54, 0
    s_and_b32 s55, s54, 3
    s_lshl_b32 s55, s55, 5
    s_lshr_b32 s56, s54, 2
    s_lshl_b32 s56, s56, 10
    s_add_u32 s56, s56, 92160
    v_xor_b32 v60, s55, v55
    v_add_u32 v60, s56, v60
    ds_read_b64_tr_b16 v[28:29], v60 offset:0
    ds_read_b64_tr_b16 v[30:31], v60 offset:6144
    ds_read_b64_tr_b16 v[32:33], v60 offset:12288
    ds_read_b64_tr_b16 v[34:35], v60 offset:18432
    ds_read_b64_tr_b16 v[36:37], v60 offset:24576
    ds_read_b64_tr_b16 v[38:39], v60 offset:30720
    s_mul_i32 s54, s9, 3
    s_add_u32 s54, s54, 1
    s_and_b32 s55, s54, 3
    s_lshl_b32 s55, s55, 5
    s_lshr_b32 s56, s54, 2
    s_lshl_b32 s56, s56, 10
    s_add_u32 s56, s56, 92160
    v_xor_b32 v60, s55, v55
    v_add_u32 v60, s56, v60
    ds_read_b64_tr_b16 v[40:41], v60 offset:0
    ds_read_b64_tr_b16 v[42:43], v60 offset:6144
    ds_read_b64_tr_b16 v[44:45], v60 offset:12288
    ds_read_b64_tr_b16 v[46:47], v60 offset:18432
    ds_read_b64_tr_b16 v[48:49], v60 offset:24576
    ds_read_b64_tr_b16 v[50:51], v60 offset:30720
    s_mul_i32 s54, s9, 3
    s_add_u32 s54, s54, 2
    s_and_b32 s55, s54, 3
    s_lshl_b32 s55, s55, 5
    s_lshr_b32 s56, s54, 2
    s_lshl_b32 s56, s56, 10
    s_add_u32 s56, s56, 92160
    v_xor_b32 v60, s55, v55
    v_add_u32 v60, s56, v60
    s_cmp_eq_u32 s9, 3
    s_cbranch_scc1 Lx_204
    v_lshrrev_b32 v2, 2, v0
    v_mul_u32_u24 v1, 384, v2
    v_lshlrev_b32 v2, 10, v2
    v_and_b32 v3, 3, v0
    v_lshl_add_u32 v1, v3, 4, v1
    s_add_u32 s28, s99, 6144
    s_add_u32 s31, s101, 16384
    s_add_u32 s29, s99, 12288
    s_add_u32 s32, s101, 32768
    s_add_u32 s30, s99, 18432
    s_add_u32 s33, s101, 49152
    s_sleep 17
    buffer_load_dwordx2 v[20:21], v2, s[20:23], s101 offen sc1
    buffer_load_dwordx2 v[22:23], v2, s[20:23], s31 offen sc1
    buffer_load_dwordx2 v[24:25], v2, s[20:23], s32 offen sc1
    buffer_load_dwordx2 v[26:27], v2, s[20:23], s33 offen sc1
    s_sleep 1
    buffer_load_dwordx4 v[4:7], v1, s[20:23], s99 offen sc1
    buffer_load_dwordx4 v[8:11], v1, s[20:23], s28 offen sc1
    buffer_load_dwordx4 v[12:15], v1, s[20:23], s29 offen sc1
    buffer_load_dwordx4 v[16:19], v1, s[20:23], s30 offen sc1
    s_mov_b32 s53, 0
    v_and_b32 v2, 32, v0
    v_lshrrev_b32 v2, 2, v2
    v_and_b32 v3, 16, v0
    v_lshl_or_b32 v2, v3, 0, v2
    v_and_b32 v3, 2, v0
    v_lshl_or_b32 v2, v3, 1, v2
    v_and_b32 v3, 1, v0
    v_lshl_or_b32 v2, v3, 5, v2
    v_and_b32 v1, 16, v0
    v_lshrrev_b32 v1, 2, v1
    v_and_b32 v3, 32, v0
    v_lshrrev_b32 v3, 1, v3
    v_or_b32 v1, v3, v1
    v_and_b32 v3, 2, v0
    v_lshl_or_b32 v1, v3, 2, v1
    v_and_b32 v3, 1, v0
    v_lshl_or_b32 v1, v3, 5, v1
    s_cmp_eq_u32 s9, 2
    s_cselect_b64 vcc, -1, 0
    s_lshl_b32 s54, s9, 6
    s_add_u32 s54, s54, 162688
    v_cndmask_b32 v2, v2, v1, vcc
    v_add_u32 v2, s54, v2
    v_mov_b64 v[52:53], 0
    v_mov_b64 v[54:55], 0
    s_waitcnt vmcnt(4)
    v_max3_f32 v3, v20, v22, v24
    v_max_f32 v3, v3, v26
    s_nop 1
    v_max_f32_dpp v3, v3, v3 row_ror:4 row_mask:0xf bank_mask:0xf
    s_nop 1
    v_max_f32_dpp v3, v3, v3 row_ror:8 row_mask:0xf bank_mask:0xf
    v_mov_b32 v1, v3
    s_nop 1
    v_permlane16_swap_b32 v3, v1
    v_max_f32 v3, v3, v1
    v_mov_b32 v1, v3
    s_nop 1
    v_permlane32_swap_b32 v3, v1
    v_max_f32 v3, v3, v1
    v_sub_f32 v20, v20, v3
    v_sub_f32 v22, v22, v3
    v_sub_f32 v24, v24, v3
    v_sub_f32 v26, v26, v3
    v_exp_f32 v20, v20
    v_exp_f32 v22, v22
    v_exp_f32 v24, v24
    v_exp_f32 v26, v26
    v_and_b32 v20, 0xffff0000, v20
    v_and_b32 v22, 0xffff0000, v22
    v_and_b32 v24, 0xffff0000, v24
    v_and_b32 v26, 0xffff0000, v26
    v_mul_f32 v3, v20, v21
    v_fmac_f32 v3, v22, v23
    v_fmac_f32 v3, v24, v25
    v_fmac_f32 v3, v26, v27
    v_lshrrev_b32 v21, 16, v20
    v_lshrrev_b32 v23, 16, v22
    v_add_f32_dpp v3, v3, v3 row_ror:4 row_mask:0xf bank_mask:0xf
    v_lshrrev_b32 v25, 16, v24
    v_lshrrev_b32 v27, 16, v26
    v_add_f32_dpp v3, v3, v3 row_ror:8 row_mask:0xf bank_mask:0xf
    v_mov_b32 v1, v3
    s_nop 1
    v_permlane16_swap_b32 v3, v1
    v_add_f32 v3, v3, v1
    v_mov_b32 v1, v3
    s_nop 1
    v_permlane32_swap_b32 v3, v1
    v_add_f32 v3, v3, v1
    v_rcp_f32 v3, v3
    s_nop 0
    v_mul_f32 v3, s0, v3
    s_waitcnt vmcnt(0)
Lc_206:
    v_dot2c_f32_bf16 v52, v4, v21
    v_dot2c_f32_bf16 v53, v5, v21
    v_dot2c_f32_bf16 v54, v6, v21
    v_dot2c_f32_bf16 v55, v7, v21
    v_dot2c_f32_bf16 v52, v8, v23
    v_dot2c_f32_bf16 v53, v9, v23
    v_dot2c_f32_bf16 v54, v10, v23
    v_dot2c_f32_bf16 v55, v11, v23
    v_dot2c_f32_bf16 v52, v12, v25
    v_dot2c_f32_bf16 v53, v13, v25
    v_dot2c_f32_bf16 v54, v14, v25
    v_dot2c_f32_bf16 v55, v15, v25
    v_dot2c_f32_bf16 v52, v16, v27
    v_dot2c_f32_bf16 v53, v17, v27
    v_dot2c_f32_bf16 v54, v18, v27
    v_dot2c_f32_bf16 v55, v19, v27
    v_dot2_f32_bf16 v4, v4, v20, 0
    v_dot2_f32_bf16 v5, v5, v20, 0
    v_dot2_f32_bf16 v6, v6, v20, 0
    v_dot2_f32_bf16 v7, v7, v20, 0
    v_permlane16_swap_b32 v52, v53
    v_dot2_f32_bf16 v4, v8, v22, v4
    v_dot2_f32_bf16 v5, v9, v22, v5
    v_permlane16_swap_b32 v54, v55
    v_dot2_f32_bf16 v6, v10, v22, v6
    v_dot2_f32_bf16 v7, v11, v22, v7
    v_add_f32 v52, v52, v53
    v_dot2_f32_bf16 v4, v12, v24, v4
    v_dot2_f32_bf16 v5, v13, v24, v5
    v_add_f32 v54, v54, v55
    v_dot2_f32_bf16 v6, v14, v24, v6
    v_dot2_f32_bf16 v7, v15, v24, v7
    v_permlane32_swap_b32 v52, v54
    v_dot2_f32_bf16 v4, v16, v26, v4
    v_dot2_f32_bf16 v5, v17, v26, v5
    v_add_f32 v52, v52, v54
    v_dot2_f32_bf16 v6, v18, v26, v6
    v_dot2_f32_bf16 v7, v19, v26, v7
    v_add_f32_dpp v52, v52, v52 row_ror:4 row_mask:0xf bank_mask:0xf
    v_permlane16_swap_b32 v4, v5
    s_nop 0
    v_add_f32_dpp v52, v52, v52 row_ror:8 row_mask:0xf bank_mask:0xf
    v_permlane16_swap_b32 v6, v7
    v_add_f32 v4, v4, v5
    v_add_f32 v6, v6, v7
    v_mul_f32 v52, v52, v3
    s_nop 0
    v_permlane32_swap_b32 v4, v6
    v_add_f32 v4, v4, v6
    s_nop 1
    v_add_f32_dpp v4, v4, v4 row_ror:4 row_mask:0xf bank_mask:0xf
    s_nop 1
    v_add_f32_dpp v4, v4, v4 row_ror:8 row_mask:0xf bank_mask:0xf
    v_mul_f32 v4, v4, v3
    v_cvt_pk_bf16_f32 v5, v52, v4
    ds_write_b32 v2, v5
    ds_read_b64_tr_b16 v[8:9], v60 offset:0
    ds_read_b64_tr_b16 v[10:11], v60 offset:6144
    ds_read_b64_tr_b16 v[12:13], v60 offset:12288
    ds_read_b64_tr_b16 v[14:15], v60 offset:18432
    ds_read_b64_tr_b16 v[16:17], v60 offset:24576
    ds_read_b64_tr_b16 v[18:19], v60 offset:30720
    v_cmp_u_f32 vcc, v52, v4
    s_cbranch_vccnz Lcold_208
Lok_207:
Lr_205:
    v_and_b32 v2, 48, v0
    v_and_b32 v3, 1, v0
    v_lshlrev_b32 v1, 1, v2
    v_add_u32 v2, 162816, v2
    v_lshl_add_u32 v1, v3, 4, v1
    s_waitcnt lgkmcnt(6)
    s_barrier
    ds_read_b128 v[24:27], v2
    v_add_u32 v1, 162688, v1
    ds_read_b128 v[20:23], v1
    v_mul_u32_u24 v3, 0xaaaa, v3
    v_or_b32 v3, 0x4444, v3
    s_mul_i32 s54, s9, 48
    v_add_u32 v60, s54, v0
    v_lshrrev_b32 v1, 6, v60
    v_mul_u32_u24 v1, 448, v1
    s_lshl_b32 s55, s6, 8
    s_lshl_b32 s56, s9, 11
    s_sub_u32 s55, s55, s56
    s_waitcnt lgkmcnt(1)
    v_mfma_f32_16x16x32_bf16 v[52:55], v[24:27], v[36:39], 0
    s_add_u32 s55, s55, 8192
    v_add_lshl_u32 v60, v60, v1, 2
    v_mfma_f32_16x16x32_bf16 v[4:7], v[24:27], v[48:51], 0
    v_add_u32 v60, s55, v60
    s_add_u32 s28, s52, 24576
    v_mfma_f32_16x16x32_bf16 v[36:39], v[24:27], v[16:19], 0
    s_add_u32 s32, s52, 16384
    s_waitcnt lgkmcnt(0)
    v_smfmac_f32_16x16x64_bf16 v[52:55], v[20:23], v[28:35], v3
    s_nop 1
    v_smfmac_f32_16x16x64_bf16 v[4:7], v[20:23], v[40:47], v3
    s_nop 1
    v_smfmac_f32_16x16x64_bf16 v[36:39], v[20:23], v[8:15], v3
    v_lshlrev_b32 v26, 2, v0
    s_cmp_eq_u32 s3, 0
    s_nop 1
    s_cbranch_scc1 Lx_214
    s_mov_b64 exec, s[36:37]
    v_add_f32_dpp v2, v52, v53 quad_perm:[0,1,2,3] row_mask:0x1 bank_mask:0xf
    v_add_f32_dpp v2, v4, v5 quad_perm:[0,1,2,3] row_mask:0x2 bank_mask:0xf
    v_add_f32_dpp v2, v36, v37 quad_perm:[0,1,2,3] row_mask:0x4 bank_mask:0xf
    buffer_store_dword v2, v60, s[20:23], s32 offen
    s_mov_b64 exec, -1
Lr_215:
    s_cmp_eq_u32 s9, 3
    s_cbranch_scc1 Lx_216
    s_sleep 5
    buffer_load_dword v4, v26, s[20:23], s28 offen offset:0 sc1
    buffer_load_dword v5, v26, s[20:23], s28 offen offset:256 sc1
    buffer_load_dword v6, v26, s[20:23], s28 offen offset:512 sc1
    buffer_load_dword v7, v26, s[20:23], s28 offen offset:768 sc1
    buffer_load_dword v8, v26, s[20:23], s28 offen offset:1024 sc1
    buffer_load_dword v9, v26, s[20:23], s28 offen offset:1280 sc1
    buffer_load_dword v10, v26, s[20:23], s28 offen offset:1536 sc1
    buffer_load_dword v11, v26, s[20:23], s28 offen offset:1792 sc1
    s_mov_b32 s53, 0
    s_lshl_b32 s54, s9, 7
    s_add_u32 s54, s54, 162304
    v_and_b32 v2, 16, v0
    v_lshrrev_b32 v2, 2, v2
    v_and_b32 v3, 37, v0
    v_lshl_or_b32 v2, v3, 1, v2
    v_and_b32 v3, 8, v0
    v_lshl_or_b32 v2, v3, 2, v2
    v_and_b32 v3, 2, v0
    v_lshl_or_b32 v2, v3, 3, v2
    v_add_u32 v2, s54, v2
    v_lshrrev_b32 v28, 2, v0
    v_mul_u32_u24 v28, 160, v28
    v_and_b32 v29, 3, v0
    v_lshl_add_u32 v28, v29, 3, v28
    s_lshl_b32 s54, s9, 5
    s_add_u32 s54, s54, 61440
    v_add_u32 v28, s54, v28
    ds_read_b64_tr_b16 v[30:31], v28 offset:0
    ds_read_b64_tr_b16 v[32:33], v28 offset:2560
    ds_read_b64_tr_b16 v[34:35], v28 offset:5120
    ds_read_b64_tr_b16 v[36:37], v28 offset:7680
    ds_read_b64_tr_b16 v[38:39], v28 offset:10240
    ds_read_b64_tr_b16 v[40:41], v28 offset:12800
    ds_read_b64_tr_b16 v[42:43], v28 offset:15360
    ds_read_b64_tr_b16 v[44:45], v28 offset:17920
    ds_read_b64_tr_b16 v[46:47], v28 offset:20480
    ds_read_b64_tr_b16 v[48:49], v28 offset:23040
    ds_read_b64_tr_b16 v[50:51], v28 offset:25600
    ds_read_b64_tr_b16 v[52:53], v28 offset:28160
    v_and_b32 v29, 1, v0
    v_lshlrev_b32 v29, 4, v29
    v_lshrrev_b32 v55, 4, v0
    v_lshl_add_u32 v55, v55, 5, v29
    v_add_u32 v55, 162304, v55
    v_and_b32 v29, 1, v0
    v_mul_u32_u24 v29, 0xaaaa, v29
    v_or_b32 v29, 0x4444, v29
    v_mov_b64 v[22:23], 0
    s_waitcnt vmcnt(0)
Lc_218:
    v_pk_add_f32 v[4:5], v[4:5], v[6:7]
    v_pk_add_f32 v[8:9], v[8:9], v[10:11]
    v_pk_add_f32 v[4:5], v[4:5], v[8:9]
    v_add_f32 v4, v4, v5
    v_cvt_pk_bf16_f32 v5, v4, v4
    ds_write_b16 v2, v5
    v_cmp_u_f32 vcc, v4, v4
    s_cbranch_vccnz Lcold_220
Lok_219:
    s_waitcnt lgkmcnt(0)
    s_barrier
    ds_read_b128 v[4:7], v55
    ds_read_b128 v[8:11], v55 offset:128
    ds_read_b128 v[12:15], v55 offset:256
    s_cmp_lt_u32 s9, 2
    s_cselect_b32 s55, 63, 59
    s_min_u32 s54, s9, 2
    s_lshl_b32 s54, s54, 3
    v_and_b32 v54, s55, v0
    v_and_b32 v60, 7, v54
    v_lshlrev_b32 v54, 4, v54
    v_add_u32 v60, s54, v60
    s_waitcnt lgkmcnt(2)
    v_smfmac_f32_16x16x64_bf16 v[22:25], v[4:7], v[30:37], v29
    s_waitcnt lgkmcnt(1)
    v_smfmac_f32_16x16x64_bf16 v[22:25], v[8:11], v[38:45], v29
    s_waitcnt lgkmcnt(0)
    v_smfmac_f32_16x16x64_bf16 v[22:25], v[12:15], v[46:53], v29
    s_mov_b64 exec, s[38:39]
    s_nop 6
    v_add_f32 v22, v22, v23
    buffer_store_dword v22, v26, s[20:23], s45 offen sc1
    s_mov_b64 exec, -1
Lr_217:
    s_cmp_lg_u32 s10, 0
    s_cbranch_scc1 L_final
    s_add_u32 s52, s52, 2097152
    s_add_u32 s63, s63, 65536
    s_add_u32 s94, s94, 65536
    s_add_u32 s95, s95, 2097152
    s_add_u32 s98, s98, 3145728
    s_add_u32 s99, s99, 3145728
    s_add_u32 s100, s100, 65536
    s_add_u32 s101, s101, 65536
    v_and_b32 v3, 1, v0
    v_lshlrev_b32 v3, 4, v3
    v_lshrrev_b32 v1, 4, v0
    v_lshl_add_u32 v1, v1, 5, v3
    v_and_b32 v3, 2, v0
    v_mul_u32_u24 v3, 96, v3
    v_add_u32 v3, 161792, v3
    v_add_u32 v1, v1, v3
    v_lshrrev_b32 v2, 4, v0
    v_lshl_add_u32 v2, v2, 3, v3
    v_add_u32 v2, 128, v2
    v_and_b32 v3, 1, v0
    v_cmp_eq_u32 vcc, 1, v3
    v_mov_b32 v3, 162144
    s_nop 0
    v_cndmask_b32 v2, v2, v3, vcc
    v_and_b32 v4, 1, v0
    v_mul_u32_u24 v4, 0xaaaa, v4
    v_or_b32 v4, 0x4444, v4
    s_lshl_b32 s54, s9, 5
    s_lshl_b32 s55, s9, 6
    s_sub_u32 s55, s55, 64
    s_cmp_lt_u32 s9, 2
    s_cselect_b32 s54, s54, s55
    v_add_u32 v5, s54, v0
    v_lshrrev_b32 v3, 6, v5
    v_mul_u32_u24 v3, 448, v3
    s_lshl_b32 s55, s6, 8
    s_lshl_b32 s56, s9, 11
    s_sub_u32 s55, s55, s56
    s_add_u32 s55, s55, 8192
    v_add_lshl_u32 v5, v5, v3, 2
    v_add_u32 v5, s55, v5
    s_add_u32 s32, s52, 4294959104
    s_mul_i32 s33, s9, 4294965252
    s_lshl_b32 s55, s6, 5
    s_add_u32 s33, s33, s55
    s_add_u32 s33, s33, s52
    s_add_u32 s33, s33, 6144
    s_add_u32 s33, s33, s1
    s_cmp_eq_u32 s9, 3
    s_cbranch_scc1 Lx_224
    v_lshrrev_b32 v55, 4, v0
    v_lshl_add_u32 v60, v60, 2, v55
    v_and_b32 v55, 16, v60
    v_lshrrev_b32 v55, 2, v55
    v_and_b32 v3, 37, v60
    v_lshl_or_b32 v55, v3, 1, v55
    v_and_b32 v3, 8, v60
    v_lshl_or_b32 v55, v3, 2, v55
    v_and_b32 v3, 2, v60
    v_lshl_or_b32 v55, v3, 3, v55
    v_cmp_gt_u32 vcc, 64, v60
    v_lshlrev_b32 v60, 1, v60
    s_nop 0
    v_cndmask_b32 v55, v60, v55, vcc
    v_add_u32 v55, 161792, v55
    ds_read_u16 v22, v55
    s_sleep 11
    buffer_load_dwordx4 v[6:9], v54, s[20:23], s46 offen offset:0 sc1
    buffer_load_dwordx4 v[10:13], v54, s[20:23], s46 offen offset:1024 sc1
    buffer_load_dwordx4 v[14:17], v54, s[20:23], s46 offen offset:2048 sc1
    buffer_load_dwordx4 v[18:21], v54, s[20:23], s46 offen offset:3072 sc1
    s_mov_b32 s53, 0
    s_waitcnt lgkmcnt(0)
    v_lshlrev_b32 v22, 16, v22
    s_waitcnt vmcnt(0)
Lc_226:
    v_pk_add_f32 v[6:7], v[6:7], v[10:11]
    v_pk_add_f32 v[14:15], v[14:15], v[18:19]
    v_pk_add_f32 v[8:9], v[8:9], v[12:13]
    v_pk_add_f32 v[6:7], v[6:7], v[14:15]
    v_pk_add_f32 v[16:17], v[16:17], v[20:21]
    v_pk_add_f32 v[8:9], v[8:9], v[16:17]
    v_permlane16_swap_b32 v6, v7
    v_add_f32 v6, v6, v7
    v_permlane16_swap_b32 v8, v9
    v_add_f32 v8, v8, v9
    s_nop 1
    v_permlane32_swap_b32 v6, v8
    v_add_f32 v6, v6, v8
    s_nop 1
    v_add_f32_dpp v6, v6, v6 row_ror:8 row_mask:0xf bank_mask:0xf
    v_cvt_pk_bf16_f32 v7, v6, v6
    v_lshlrev_b32 v7, 16, v7
    v_add_f32 v7, v7, v22
    v_cvt_pk_bf16_f32 v20, v7, v7
    ds_write_b16 v55, v20
    v_cmp_u_f32 vcc, v6, v6
    s_cbranch_vccnz Lcold_228
Lok_227:
    v_lshlrev_b32 v3, 16, v20
    v_cndmask_b32 v3, 0, v3, s[58:59]
    s_nop 1
    v_mul_f32_dpp v3, v3, v3 quad_perm:[0,1,2,3] row_mask:0xf bank_mask:0x3
Lr_225:
    s_mov_b32 s10, 1
    s_mov_b32 s49, -2
    s_waitcnt lgkmcnt(0)
    s_barrier
    s_branch L_top
L_final:
    s_add_u32 s54, s1, s5
    s_cmp_lg_u32 s54, 0
    s_cbranch_scc1 L_exit
    s_mov_b32 s24, s86
    s_mov_b32 s25, s87
    s_mov_b32 s26, 1280
    s_mov_b32 s27, 0x00020000
    s_mul_i32 s28, s6, 160
    v_lshrrev_b32 v55, 4, v0
    v_lshl_add_u32 v60, v60, 2, v55
    v_and_b32 v55, 16, v60
    v_lshrrev_b32 v55, 2, v55
    v_and_b32 v3, 37, v60
    v_lshl_or_b32 v55, v3, 1, v55
    v_and_b32 v3, 8, v60
    v_lshl_or_b32 v55, v3, 2, v55
    v_and_b32 v3, 2, v60
    v_lshl_or_b32 v55, v3, 3, v55
    v_cmp_gt_u32 vcc, 64, v60
    v_lshlrev_b32 v60, 1, v60
    s_nop 0
    v_cndmask_b32 v55, v60, v55, vcc
    v_add_u32 v55, 161792, v55
    ds_read_u16 v22, v55
    buffer_load_dwordx4 v[6:9], v54, s[20:23], s46 offen offset:0 sc1
    buffer_load_dwordx4 v[10:13], v54, s[20:23], s46 offen offset:1024 sc1
    buffer_load_dwordx4 v[14:17], v54, s[20:23], s46 offen offset:2048 sc1
    buffer_load_dwordx4 v[18:21], v54, s[20:23], s46 offen offset:3072 sc1
    s_mov_b32 s53, 0
    s_waitcnt lgkmcnt(0)
    v_lshlrev_b32 v22, 16, v22
    s_waitcnt vmcnt(0)
Lc_232:
    v_pk_add_f32 v[6:7], v[6:7], v[10:11]
    v_pk_add_f32 v[14:15], v[14:15], v[18:19]
    v_pk_add_f32 v[8:9], v[8:9], v[12:13]
    v_pk_add_f32 v[6:7], v[6:7], v[14:15]
    v_pk_add_f32 v[16:17], v[16:17], v[20:21]
    v_pk_add_f32 v[8:9], v[8:9], v[16:17]
    v_permlane16_swap_b32 v6, v7
    v_add_f32 v6, v6, v7
    v_permlane16_swap_b32 v8, v9
    v_add_f32 v8, v8, v9
    s_nop 1
    v_permlane32_swap_b32 v6, v8
    v_add_f32 v6, v6, v8
    s_nop 1
    v_add_f32_dpp v6, v6, v6 row_ror:8 row_mask:0xf bank_mask:0xf
    v_cvt_pk_bf16_f32 v7, v6, v6
    v_lshlrev_b32 v7, 16, v7
    v_add_f32 v7, v7, v22
    v_cvt_pk_bf16_f32 v20, v7, v7
    v_cmp_u_f32 vcc, v6, v6
    s_cbranch_vccnz Lcold_234
Lok_233:
    buffer_store_short v20, v60, s[24:27], s28 offen
    s_add_u32 s28, s4, s9
    s_cmp_lg_u32 s28, 0
    s_cbranch_scc1 L_exit
    v_mov_b32 v1, s62
    v_mov_b32 v2, 5046272
    s_mov_b64 exec, s[40:41]
    buffer_store_dword v1, v2, s[20:23], 0 offen
    s_mov_b64 exec, -1
L_exit:
    s_branch L_end
Lx_3:
    s_mov_b64 exec, 0x101
    buffer_store_dword v3, v1, s[20:23], s33 offen sc1
    s_mov_b64 exec, s[60:61]
    v_add_f32_dpp v2, v24, v25 quad_perm:[0,1,2,3] row_mask:0x1 bank_mask:0xf
    v_add_f32_dpp v2, v28, v29 quad_perm:[0,1,2,3] row_mask:0x2 bank_mask:0xf
    v_add_f32_dpp v2, v32, v33 quad_perm:[0,1,2,3] row_mask:0x4 bank_mask:0xf
    v_add_f32_dpp v2, v36, v37 quad_perm:[0,1,2,3] row_mask:0x8 bank_mask:0xf
    buffer_store_dword v2, v5, s[20:23], s32 offen sc1
    s_mov_b64 exec, -1
    s_branch Lr_4
Lx_1:
    v_add_f32_dpp v2, v24, v25 quad_perm:[0,1,2,3] row_mask:0x1 bank_mask:0xf
    v_add_f32_dpp v2, v28, v29 quad_perm:[0,1,2,3] row_mask:0x2 bank_mask:0xf
    v_add_f32_dpp v2, v32, v33 quad_perm:[0,1,2,3] row_mask:0x4 bank_mask:0xf
    v_add_f32_dpp v2, v36, v37 quad_perm:[0,1,2,3] row_mask:0x8 bank_mask:0xf
    v_add_f32_dpp v6, v26, v27 quad_perm:[0,1,2,3] row_mask:0x1 bank_mask:0xf
    v_add_f32_dpp v6, v30, v31 quad_perm:[0,1,2,3] row_mask:0x2 bank_mask:0xf
    v_add_f32_dpp v6, v34, v35 quad_perm:[0,1,2,3] row_mask:0x4 bank_mask:0xf
    v_add_f32_dpp v6, v38, v39 quad_perm:[0,1,2,3] row_mask:0x8 bank_mask:0xf
    s_lshl_b32 s54, s9, 7
    s_lshl_b32 s55, s9, 8
    s_sub_u32 s55, s55, 256
    s_cmp_lt_u32 s9, 2
    s_cselect_b32 s54, s54, s55
    s_add_u32 s54, s54, 153600
    v_lshl_add_u32 v5, v0, 2, s54
    s_lshl_b32 s54, s9, 2
    s_add_u32 s54, s54, 154368
    v_add_u32 v1, s54, v1
    s_getreg_b32 s55, hwreg(HW_REG_XCC_ID, 0, 4)
    s_cmp_eq_u32 s9, 3
    s_cselect_b64 vcc, -1, 0
    v_mov_b32 v7, s55
    v_cndmask_b32 v3, v3, v7, vcc
    s_mov_b64 exec, s[60:61]
    ds_write_b32 v5, v2
    ds_write_b32 v5, v6 offset:1024
    s_mov_b64 exec, 0x101
    ds_write_b32 v1, v3
    s_mov_b64 exec, -1
    s_waitcnt lgkmcnt(0)
    s_barrier
    s_cmp_lg_u32 s9, 3
    s_cbranch_scc1 Ls_5
    v_mov_b32 v4, -1
    v_mov_b32 v5, -1
    v_mov_b32 v6, -1
    v_mov_b32 v7, -1
    v_lshlrev_b32 v8, 4, v0
    v_lshrrev_b32 v10, 4, v0
    v_mul_u32_u24 v10, 1792, v10
    v_lshl_add_u32 v9, v0, 4, v10
    s_lshl_b32 s55, s6, 8
    s_mul_i32 s56, s6, 224
    v_add_u32 v9, s55, v9
    v_subrev_u32 v10, s56, v9
    v_cmp_gt_u32 vcc, 48, v0
    s_sub_u32 s54, s52, 6144
    s_nop 0
    v_cndmask_b32 v9, v10, v9, vcc
    v_add_u32 v2, 153600, v8
    ds_read_b128 v[12:15], v2
    ds_read_b128 v[16:19], v2 offset:1024
    s_add_u32 s29, s54, 8192
    s_add_u32 s30, s54, 32768
    s_mov_b32 exec_hi, 0x3ffff
    buffer_store_dwordx4 v[4:7], v9, s[20:23], s29 offen sc1
    s_waitcnt lgkmcnt(0)
    buffer_store_dwordx4 v[12:15], v9, s[20:23], s54 offen sc1
    s_mov_b64 exec, s[36:37]
    buffer_store_dwordx4 v[16:19], v9, s[20:23], s30 offen sc1
    s_mov_b64 exec, -1
    v_lshrrev_b32 v10, 3, v0
    v_mul_u32_u24 v10, 3968, v10
    v_add_u32 v10, v10, v8
    s_mov_b64 exec, 0xffffff
    s_add_u32 s28, s45, 4294963136
    buffer_store_dwordx4 v[4:7], v10, s[20:23], s28 offen sc1
    s_mov_b64 exec, -1
    s_nop 0
    v_mov_b32 v4, -1
    v_mov_b32 v5, -1
    v_mov_b32 v6, -1
    v_mov_b32 v7, -1
    v_lshlrev_b32 v8, 4, v0
    v_lshrrev_b32 v10, 4, v0
    v_mul_u32_u24 v10, 1792, v10
    v_lshl_add_u32 v9, v0, 4, v10
    s_lshl_b32 s55, s6, 8
    s_mul_i32 s56, s6, 224
    v_add_u32 v9, s55, v9
    v_subrev_u32 v10, s56, v9
    v_cmp_gt_u32 vcc, 48, v0
    s_sub_u32 s54, s52, 6144
    s_nop 0
    v_cndmask_b32 v9, v10, v9, vcc
    s_add_u32 s28, s54, 16384
    s_add_u32 s29, s54, 24576
    s_add_u32 s30, s54, 40960
    s_mov_b32 exec_hi, 0x3ffff
    buffer_store_dwordx4 v[4:7], v9, s[20:23], s28 offen sc1
    buffer_store_dwordx4 v[4:7], v9, s[20:23], s29 offen sc1
    buffer_store_dwordx4 v[4:7], v9, s[20:23], s30 offen sc1
    s_mov_b64 exec, -1
    v_lshrrev_b32 v10, 3, v0
    v_mul_u32_u24 v10, 3968, v10
    v_add_u32 v10, v10, v8
    s_mov_b64 exec, 0xffffff
    s_add_u32 s28, s45, 94144
    buffer_store_dwordx4 v[4:7], v10, s[20:23], s28 offen sc1
    s_add_u32 s28, s45, 192448
    buffer_store_dwordx4 v[4:7], v10, s[20:23], s28 offen sc1
    s_add_u32 s28, s45, 290752
    buffer_store_dwordx4 v[4:7], v10, s[20:23], s28 offen sc1
    s_mov_b64 exec, -1
    s_add_u32 s28, s63, 4294965216
    s_mov_b64 exec, 0xfff
    v_lshrrev_b32 v10, 2, v0
    v_mul_u32_u24 v10, 960, v10
    v_add_u32 v10, v10, v8
    buffer_store_dwordx4 v[4:7], v10, s[20:23], s28 offen sc1
    s_lshl_b32 s28, s4, 8
    s_add_u32 s28, s28, 4849664
    s_mov_b64 exec, s[38:39]
    buffer_store_dwordx4 v[4:7], v8, s[20:23], s28 offen sc1
    s_mov_b64 exec, -1
    s_add_u32 s28, s63, 63456
    s_mov_b64 exec, 0xfff
    v_lshrrev_b32 v10, 2, v0
    v_mul_u32_u24 v10, 960, v10
    v_add_u32 v10, v10, v8
    buffer_store_dwordx4 v[4:7], v10, s[20:23], s28 offen sc1
    s_lshl_b32 s28, s4, 8
    s_add_u32 s28, s28, 4915200
    s_mov_b64 exec, s[38:39]
    buffer_store_dwordx4 v[4:7], v8, s[20:23], s28 offen sc1
    s_mov_b64 exec, -1
    s_nop 0
    v_mov_b32 v4, -1
    v_mov_b32 v5, -1
    v_mov_b32 v6, -1
    v_mov_b32 v7, -1
    v_lshlrev_b32 v8, 4, v0
    v_lshrrev_b32 v10, 4, v0
    v_mul_u32_u24 v10, 1792, v10
    v_lshl_add_u32 v9, v0, 4, v10
    s_lshl_b32 s55, s6, 8
    s_mul_i32 s56, s6, 224
    v_add_u32 v9, s55, v9
    v_subrev_u32 v10, s56, v9
    v_cmp_gt_u32 vcc, 48, v0
    s_sub_u32 s54, s52, 6144
    s_nop 0
    v_cndmask_b32 v9, v10, v9, vcc
    s_add_u32 s28, s54, 2097152
    s_add_u32 s29, s54, 2105344
    s_add_u32 s30, s54, 2113536
    s_add_u32 s31, s54, 2121728
    s_mov_b32 exec_hi, 0x3ffff
    buffer_store_dwordx4 v[4:7], v9, s[20:23], s28 offen sc1
    buffer_store_dwordx4 v[4:7], v9, s[20:23], s29 offen sc1
    buffer_store_dwordx4 v[4:7], v9, s[20:23], s30 offen sc1
    buffer_store_dwordx4 v[4:7], v9, s[20:23], s31 offen sc1
    s_mov_b64 exec, -1
Ls_5:
    s_branch Lr_2
Lx_6:
    v_lshl_add_u32 v2, v0, 3, s6
    s_lshl_b32 s54, s5, 3
    v_and_b32 v3, 7, v0
    v_add_u32 v3, s54, v3
    v_cmp_gt_u32 vcc, 32, v0
    s_mov_b32 s34, 4980736
    s_nop 0
    v_cndmask_b32 v2, v3, v2, vcc
    v_lshlrev_b32 v2, 7, v2
    v_and_b32 v46, 7, v0
    v_and_b32 v47, 6, v0
    v_lshrrev_b32 v1, 4, v0
    v_xor_b32 v47, v47, v1
    v_lshlrev_b32 v46, 7, v46
    v_lshl_add_u32 v46, v47, 4, v46
    v_bfe_u32 v47, v0, 3, 1
    v_mul_u32_u24 v47, 3072, v47
    v_add3_u32 v46, v46, v47, s57
    v_xor_b32 v47, 64, v46
    s_cmp_eq_u32 s9, 3
    s_cbranch_scc1 Ls_8
    s_waitcnt vmcnt(6)
Ls_8:
    s_waitcnt vmcnt(18)
    s_add_u32 m0, s57, 12288
    s_add_u32 s35, s11, 12288
    buffer_load_dwordx4 v44, s[12:15], s35 offen nt lds
    s_cmp_eq_u32 s9, 3
    s_cbranch_scc1 Ls_9
    s_waitcnt vmcnt(6)
Ls_9:
    s_add_u32 m0, s57, 13312
    s_add_u32 s35, s11, 12416
    buffer_load_dwordx4 v44, s[12:15], s35 offen nt lds
    s_cmp_eq_u32 s9, 3
    s_cbranch_scc1 Ls_10
    s_waitcnt vmcnt(6)
Ls_10:
    s_add_u32 m0, s57, 14336
    s_add_u32 s35, s11, 12544
    buffer_load_dwordx4 v44, s[12:15], s35 offen nt lds
    s_cmp_eq_u32 s9, 3
    s_cbranch_scc1 Ls_11
    s_waitcnt vmcnt(6)
Ls_11:
    s_add_u32 m0, s57, 15360
    s_add_u32 s35, s11, 15360
    buffer_load_dwordx4 v44, s[12:15], s35 offen nt lds
    s_cmp_eq_u32 s9, 3
    s_cbranch_scc1 Ls_12
    s_waitcnt vmcnt(6)
Ls_12:
    s_add_u32 m0, s57, 16384
    s_add_u32 s35, s11, 15488
    buffer_load_dwordx4 v44, s[12:15], s35 offen nt lds
    s_cmp_eq_u32 s9, 3
    s_cbranch_scc1 Ls_13
    s_waitcnt vmcnt(6)
Ls_13:
    s_add_u32 m0, s57, 17408
    s_add_u32 s35, s11, 15616
    buffer_load_dwordx4 v44, s[12:15], s35 offen nt lds
    s_waitcnt lgkmcnt(0)
    ds_read_b128 a[0:3], v46 offset:0
    ds_read_b128 a[4:7], v47 offset:0
    ds_read_b128 a[8:11], v46 offset:1024
    ds_read_b128 a[12:15], v47 offset:1024
    ds_read_b128 a[16:19], v46 offset:2048
    ds_read_b128 a[20:23], v47 offset:2048
    s_cmp_eq_u32 s9, 3
    s_cbranch_scc1 Ls_14
    s_waitcnt vmcnt(6)
Ls_14:
    s_add_u32 m0, s57, 18432
    s_add_u32 s35, s11, 12672
    buffer_load_dwordx4 v44, s[12:15], s35 offen nt lds
    s_cmp_eq_u32 s9, 3
    s_cbranch_scc1 Ls_15
    s_waitcnt vmcnt(6)
Ls_15:
    s_add_u32 m0, s57, 19456
    s_add_u32 s35, s11, 12800
    buffer_load_dwordx4 v44, s[12:15], s35 offen nt lds
    s_cmp_eq_u32 s9, 3
    s_cbranch_scc1 Ls_16
    s_waitcnt vmcnt(6)
Ls_16:
    s_add_u32 m0, s57, 20480
    s_add_u32 s35, s11, 12928
    buffer_load_dwordx4 v44, s[12:15], s35 offen nt lds
    s_cmp_eq_u32 s9, 3
    s_cbranch_scc1 Ls_17
    s_waitcnt vmcnt(6)
Ls_17:
    s_add_u32 m0, s57, 21504
    s_add_u32 s35, s11, 15744
    buffer_load_dwordx4 v44, s[12:15], s35 offen nt lds
    s_cmp_eq_u32 s9, 3
    s_cbranch_scc1 Ls_18
    s_waitcnt vmcnt(6)
Ls_18:
    s_add_u32 m0, s57, 22528
    s_add_u32 s35, s11, 15872
    buffer_load_dwordx4 v44, s[12:15], s35 offen nt lds
    s_cmp_eq_u32 s9, 3
    s_cbranch_scc1 Ls_19
    s_waitcnt vmcnt(6)
Ls_19:
    s_add_u32 m0, s57, 23552
    s_add_u32 s35, s11, 16000
    buffer_load_dwordx4 v44, s[12:15], s35 offen nt lds
    s_waitcnt lgkmcnt(0)
    ds_read_b128 a[24:27], v46 offset:6144
    ds_read_b128 a[28:31], v47 offset:6144
    ds_read_b128 a[32:35], v46 offset:7168
    ds_read_b128 a[36:39], v47 offset:7168
    ds_read_b128 a[40:43], v46 offset:8192
    ds_read_b128 a[44:47], v47 offset:8192
    s_cmp_eq_u32 s9, 3
    s_cbranch_scc1 Ls_20
    s_waitcnt vmcnt(6)
Ls_20:
    s_add_u32 m0, s57, 24576
    s_add_u32 s35, s11, 24576
    buffer_load_dwordx4 v44, s[12:15], s35 offen nt lds
    s_cmp_eq_u32 s9, 3
    s_cbranch_scc1 Ls_21
    s_waitcnt vmcnt(6)
Ls_21:
    s_add_u32 m0, s57, 25600
    s_add_u32 s35, s11, 24704
    buffer_load_dwordx4 v44, s[12:15], s35 offen nt lds
    s_cmp_eq_u32 s9, 3
    s_cbranch_scc1 Ls_22
    s_waitcnt vmcnt(6)
Ls_22:
    s_add_u32 m0, s57, 26624
    s_add_u32 s35, s11, 24832
    buffer_load_dwordx4 v44, s[12:15], s35 offen nt lds
    s_cmp_eq_u32 s9, 3
    s_cbranch_scc1 Ls_23
    s_waitcnt vmcnt(6)
Ls_23:
    s_add_u32 m0, s57, 27648
    s_add_u32 s35, s11, 27648
    buffer_load_dwordx4 v44, s[12:15], s35 offen nt lds
    s_cmp_eq_u32 s9, 3
    s_cbranch_scc1 Ls_24
    s_waitcnt vmcnt(6)
Ls_24:
    s_waitcnt vmcnt(7)
    s_add_u32 m0, s57, 28672
    s_add_u32 s35, s11, 27776
    buffer_load_dwordx4 v44, s[12:15], s35 offen nt lds
    s_cmp_eq_u32 s9, 3
    s_cbranch_scc1 Ls_25
    s_waitcnt vmcnt(6)
Ls_25:
    s_waitcnt vmcnt(7)
    s_add_u32 m0, s57, 29696
    s_add_u32 s35, s11, 27904
    buffer_load_dwordx4 v44, s[12:15], s35 offen nt lds
    s_waitcnt lgkmcnt(0)
    ds_read_b128 a[48:51], v46 offset:12288
    ds_read_b128 a[52:55], v47 offset:12288
    ds_read_b128 a[56:59], v46 offset:13312
    ds_read_b128 a[60:63], v47 offset:13312
    ds_read_b128 a[64:67], v46 offset:14336
    ds_read_b128 a[68:71], v47 offset:14336
    s_cmp_lg_u32 s9, 3
    s_cbranch_scc1 Ls_26
    v_mov_b32 v1, s62
    s_lshl_b32 s54, s4, 7
    v_mov_b32 v3, s54
    s_mov_b64 exec, s[40:41]
    buffer_store_dword v1, v3, s[20:23], s34 offen sc1
    s_mov_b64 exec, -1
Ls_26:
    s_cmp_eq_u32 s9, 3
    s_cbranch_scc1 Ls_27
    s_waitcnt vmcnt(6)
Ls_27:
    s_waitcnt vmcnt(7)
    s_add_u32 m0, s57, 0
    s_add_u32 s35, s11, 24960
    buffer_load_dwordx4 v44, s[12:15], s35 offen nt lds
    s_cmp_eq_u32 s9, 3
    s_cbranch_scc1 Ls_28
    s_waitcnt vmcnt(6)
Ls_28:
    s_waitcnt vmcnt(7)
    s_add_u32 m0, s57, 1024
    s_add_u32 s35, s11, 25088
    buffer_load_dwordx4 v44, s[12:15], s35 offen nt lds
    s_cmp_eq_u32 s9, 3
    s_cbranch_scc1 Ls_29
    s_waitcnt vmcnt(6)
Ls_29:
    s_waitcnt vmcnt(7)
    s_add_u32 m0, s57, 2048
    s_add_u32 s35, s11, 25216
    buffer_load_dwordx4 v44, s[12:15], s35 offen nt lds
    s_cmp_eq_u32 s9, 3
    s_cbranch_scc1 Ls_30
    s_waitcnt vmcnt(6)
Ls_30:
    s_waitcnt vmcnt(7)
    s_add_u32 m0, s57, 3072
    s_add_u32 s35, s11, 28032
    buffer_load_dwordx4 v44, s[12:15], s35 offen nt lds
    s_cmp_eq_u32 s9, 3
    s_cbranch_scc1 Ls_31
    s_waitcnt vmcnt(6)
Ls_31:
    s_waitcnt vmcnt(7)
    s_add_u32 m0, s57, 4096
    s_add_u32 s35, s11, 28160
    buffer_load_dwordx4 v44, s[12:15], s35 offen nt lds
    s_cmp_eq_u32 s9, 3
    s_cbranch_scc1 Ls_32
    s_waitcnt vmcnt(6)
Ls_32:
    s_waitcnt vmcnt(7)
    s_add_u32 m0, s57, 5120
    s_add_u32 s35, s11, 28288
    buffer_load_dwordx4 v44, s[12:15], s35 offen nt lds
    s_waitcnt lgkmcnt(0)
    ds_read_b128 a[72:75], v46 offset:18432
    ds_read_b128 a[76:79], v47 offset:18432
    ds_read_b128 a[80:83], v46 offset:19456
    ds_read_b128 a[84:87], v47 offset:19456
    ds_read_b128 a[88:91], v46 offset:20480
    ds_read_b128 a[92:95], v47 offset:20480
    s_cmp_eq_u32 s9, 3
    s_cbranch_scc1 Ls_33
    s_waitcnt vmcnt(6)
Ls_33:
    s_waitcnt vmcnt(7)
    s_add_u32 m0, s57, 6144
    s_add_u32 s35, s11, 36864
    buffer_load_dwordx4 v44, s[12:15], s35 offen nt lds
    s_cmp_eq_u32 s9, 3
    s_cbranch_scc1 Ls_34
    s_waitcnt vmcnt(6)
Ls_34:
    s_add_u32 m0, s57, 7168
    s_add_u32 s35, s11, 36992
    buffer_load_dwordx4 v44, s[12:15], s35 offen nt lds
    s_cmp_eq_u32 s9, 3
    s_cbranch_scc1 Ls_35
    s_waitcnt vmcnt(6)
Ls_35:
    s_add_u32 m0, s57, 8192
    s_add_u32 s35, s11, 37120
    buffer_load_dwordx4 v44, s[12:15], s35 offen nt lds
    s_cmp_eq_u32 s9, 3
    s_cbranch_scc1 Ls_36
    s_waitcnt vmcnt(6)
Ls_36:
    s_add_u32 m0, s57, 9216
    s_add_u32 s35, s11, 39936
    buffer_load_dwordx4 v44, s[12:15], s35 offen nt lds
    s_cmp_eq_u32 s9, 3
    s_cbranch_scc1 Ls_37
    s_waitcnt vmcnt(6)
Ls_37:
    s_add_u32 m0, s57, 10240
    s_add_u32 s35, s11, 40064
    buffer_load_dwordx4 v44, s[12:15], s35 offen nt lds
    s_cmp_eq_u32 s9, 3
    s_cbranch_scc1 Ls_38
    s_waitcnt vmcnt(6)
Ls_38:
    s_add_u32 m0, s57, 11264
    s_add_u32 s35, s11, 40192
    buffer_load_dwordx4 v44, s[12:15], s35 offen nt lds
    s_waitcnt lgkmcnt(0)
    ds_read_b128 a[96:99], v46 offset:24576
    ds_read_b128 a[100:103], v47 offset:24576
    ds_read_b128 a[104:107], v46 offset:25600
    ds_read_b128 a[108:111], v47 offset:25600
    ds_read_b128 a[112:115], v46 offset:26624
    ds_read_b128 a[116:119], v47 offset:26624
    s_cmp_eq_u32 s9, 3
    s_cbranch_scc1 Ls_39
    s_waitcnt vmcnt(6)
Ls_39:
    s_add_u32 m0, s57, 12288
    s_add_u32 s35, s11, 37248
    buffer_load_dwordx4 v44, s[12:15], s35 offen nt lds
    s_cmp_eq_u32 s9, 3
    s_cbranch_scc1 Ls_40
    s_waitcnt vmcnt(6)
Ls_40:
    s_add_u32 m0, s57, 13312
    s_add_u32 s35, s11, 37376
    buffer_load_dwordx4 v44, s[12:15], s35 offen nt lds
    s_cmp_eq_u32 s9, 3
    s_cbranch_scc1 Ls_41
    s_waitcnt vmcnt(6)
Ls_41:
    s_add_u32 m0, s57, 14336
    s_add_u32 s35, s11, 37504
    buffer_load_dwordx4 v44, s[12:15], s35 offen nt lds
    s_cmp_eq_u32 s9, 3
    s_cbranch_scc1 Ls_42
    s_waitcnt vmcnt(6)
Ls_42:
    s_add_u32 m0, s57, 15360
    s_add_u32 s35, s11, 40320
    buffer_load_dwordx4 v44, s[12:15], s35 offen nt lds
    s_cmp_eq_u32 s9, 3
    s_cbranch_scc1 Ls_43
    s_waitcnt vmcnt(6)
Ls_43:
    s_waitcnt vmcnt(7)
    s_add_u32 m0, s57, 16384
    s_add_u32 s35, s11, 40448
    buffer_load_dwordx4 v44, s[12:15], s35 offen nt lds
    s_cmp_eq_u32 s9, 3
    s_cbranch_scc1 Ls_44
    s_waitcnt vmcnt(6)
Ls_44:
    s_waitcnt vmcnt(7)
    s_add_u32 m0, s57, 17408
    s_add_u32 s35, s11, 40576
    buffer_load_dwordx4 v44, s[12:15], s35 offen nt lds
    s_waitcnt lgkmcnt(0)
    ds_read_b128 a[120:123], v46 offset:0
    ds_read_b128 a[124:127], v47 offset:0
    ds_read_b128 a[128:131], v46 offset:1024
    ds_read_b128 a[132:135], v47 offset:1024
    ds_read_b128 a[136:139], v46 offset:2048
    ds_read_b128 a[140:143], v47 offset:2048
    s_cmp_eq_u32 s9, 3
    s_cbranch_scc1 Ls_45
    s_waitcnt vmcnt(6)
Ls_45:
    s_waitcnt vmcnt(7)
    s_add_u32 m0, s57, 18432
    s_add_u32 s35, s11, 0
    buffer_load_dwordx4 v45, s[16:19], s35 offen nt lds
    s_cmp_eq_u32 s9, 3
    s_cbranch_scc1 Ls_46
    s_waitcnt vmcnt(6)
Ls_46:
    s_waitcnt vmcnt(7)
    s_add_u32 m0, s57, 19456
    s_add_u32 s35, s11, 128
    buffer_load_dwordx4 v45, s[16:19], s35 offen nt lds
    s_cmp_eq_u32 s9, 3
    s_cbranch_scc1 Ls_47
    s_waitcnt vmcnt(6)
Ls_47:
    s_waitcnt vmcnt(7)
    s_add_u32 m0, s57, 20480
    s_add_u32 s35, s11, 256
    buffer_load_dwordx4 v45, s[16:19], s35 offen nt lds
    s_cmp_eq_u32 s9, 3
    s_cbranch_scc1 Ls_48
    s_waitcnt vmcnt(6)
Ls_48:
    s_waitcnt vmcnt(7)
    s_add_u32 m0, s57, 21504
    s_add_u32 s35, s11, 3072
    buffer_load_dwordx4 v45, s[16:19], s35 offen nt lds
    s_cmp_eq_u32 s9, 3
    s_cbranch_scc1 Ls_49
    s_waitcnt vmcnt(6)
Ls_49:
    s_waitcnt vmcnt(7)
    s_add_u32 m0, s57, 22528
    s_add_u32 s35, s11, 3200
    buffer_load_dwordx4 v45, s[16:19], s35 offen nt lds
    s_cmp_eq_u32 s9, 3
    s_cbranch_scc1 Ls_50
    s_waitcnt vmcnt(6)
Ls_50:
    s_waitcnt vmcnt(7)
    s_add_u32 m0, s57, 23552
    s_add_u32 s35, s11, 3328
    buffer_load_dwordx4 v45, s[16:19], s35 offen nt lds
    s_waitcnt lgkmcnt(0)
    ds_read_b128 a[144:147], v46 offset:6144
    ds_read_b128 a[148:151], v47 offset:6144
    ds_read_b128 a[152:155], v46 offset:7168
    ds_read_b128 a[156:159], v47 offset:7168
    ds_read_b128 a[160:163], v46 offset:8192
    ds_read_b128 a[164:167], v47 offset:8192
    s_cmp_eq_u32 s9, 3
    s_cbranch_scc1 Ls_51
    buffer_load_dword v6, v2, s[20:23], s34 offen sc1
Ls_51:
    s_cmp_eq_u32 s9, 3
    s_cbranch_scc1 Ls_52
    s_waitcnt vmcnt(6)
Ls_52:
    s_waitcnt vmcnt(7)
    s_add_u32 m0, s57, 24576
    s_add_u32 s35, s11, 6144
    buffer_load_dwordx4 v45, s[16:19], s35 offen nt lds
    s_cmp_eq_u32 s9, 3
    s_cbranch_scc1 Ls_53
    s_waitcnt vmcnt(6)
Ls_53:
    s_waitcnt vmcnt(7)
    s_add_u32 m0, s57, 25600
    s_add_u32 s35, s11, 6272
    buffer_load_dwordx4 v45, s[16:19], s35 offen nt lds
    s_cmp_eq_u32 s9, 3
    s_cbranch_scc1 Ls_54
    s_waitcnt vmcnt(6)
Ls_54:
    s_waitcnt vmcnt(7)
    s_add_u32 m0, s57, 26624
    s_add_u32 s35, s11, 6400
    buffer_load_dwordx4 v45, s[16:19], s35 offen nt lds
    s_cmp_eq_u32 s9, 3
    s_cbranch_scc1 Ls_55
    s_waitcnt vmcnt(6)
Ls_55:
    s_waitcnt vmcnt(7)
    s_add_u32 m0, s57, 27648
    s_add_u32 s35, s11, 9216
    buffer_load_dwordx4 v45, s[16:19], s35 offen nt lds
    s_cmp_eq_u32 s9, 3
    s_cbranch_scc1 Ls_56
    s_waitcnt vmcnt(6)
Ls_56:
    s_waitcnt vmcnt(7)
    s_add_u32 m0, s57, 28672
    s_add_u32 s35, s11, 9344
    buffer_load_dwordx4 v45, s[16:19], s35 offen nt lds
    s_cmp_eq_u32 s9, 3
    s_cbranch_scc1 Ls_57
    s_waitcnt vmcnt(6)
Ls_57:
    s_waitcnt vmcnt(7)
    s_add_u32 m0, s57, 29696
    s_add_u32 s35, s11, 9472
    buffer_load_dwordx4 v45, s[16:19], s35 offen nt lds
    s_waitcnt lgkmcnt(0)
    ds_read_b128 a[168:171], v46 offset:12288
    ds_read_b128 a[172:175], v47 offset:12288
    ds_read_b128 a[176:179], v46 offset:13312
    ds_read_b128 a[180:183], v47 offset:13312
    ds_read_b128 a[184:187], v46 offset:14336
    ds_read_b128 a[188:191], v47 offset:14336
    s_waitcnt vmcnt(7)
    s_add_u32 m0, s57, 0
    s_add_u32 s35, s11, 12288
    buffer_load_dwordx4 v45, s[16:19], s35 offen nt lds
    s_cmp_lg_u32 s9, 3
    s_cbranch_scc1 Ls_58
    s_waitcnt vmcnt(7)
Ls_58:
    s_add_u32 m0, s57, 1024
    s_add_u32 s35, s11, 12416
    buffer_load_dwordx4 v45, s[16:19], s35 offen nt lds
    s_cmp_lg_u32 s9, 3
    s_cbranch_scc1 Ls_59
    s_waitcnt vmcnt(7)
Ls_59:
    s_add_u32 m0, s57, 2048
    s_add_u32 s35, s11, 12544
    buffer_load_dwordx4 v45, s[16:19], s35 offen nt lds
    s_cmp_lg_u32 s9, 3
    s_cbranch_scc1 Ls_60
    s_waitcnt vmcnt(7)
Ls_60:
    s_add_u32 m0, s57, 3072
    s_add_u32 s35, s11, 15360
    buffer_load_dwordx4 v45, s[16:19], s35 offen nt lds
    s_cmp_lg_u32 s9, 3
    s_cbranch_scc1 Ls_61
    s_waitcnt vmcnt(7)
Ls_61:
    s_add_u32 m0, s57, 4096
    s_add_u32 s35, s11, 15488
    buffer_load_dwordx4 v45, s[16:19], s35 offen nt lds
    s_cmp_lg_u32 s9, 3
    s_cbranch_scc1 Ls_62
    s_waitcnt vmcnt(7)
Ls_62:
    s_add_u32 m0, s57, 5120
    s_add_u32 s35, s11, 15616
    buffer_load_dwordx4 v45, s[16:19], s35 offen nt lds
    v_bfe_u32 v46, v0, 2, 3
    v_and_b32 v1, 6, v46
    v_lshlrev_b32 v46, 7, v46
    v_lshl_add_u32 v46, v1, 4, v46
    v_and_b32 v1, 3, v0
    v_lshl_add_u32 v46, v1, 3, v46
    v_lshrrev_b32 v1, 5, v0
    v_mul_u32_u24 v1, 3072, v1
    v_add_u32 v46, v46, v1
    v_add_u32 v46, s57, v46
    v_xor_b32 v47, 32, v46
    v_xor_b32 v48, 64, v46
    v_xor_b32 v49, 96, v46
    s_waitcnt lgkmcnt(0)
    ds_read_b64_tr_b16 v[64:65], v46 offset:18432
    ds_read_b64_tr_b16 v[72:73], v47 offset:18432
    ds_read_b64_tr_b16 v[80:81], v48 offset:18432
    ds_read_b64_tr_b16 v[88:89], v49 offset:18432
    ds_read_b64_tr_b16 v[96:97], v46 offset:19456
    ds_read_b64_tr_b16 v[104:105], v47 offset:19456
    ds_read_b64_tr_b16 v[112:113], v48 offset:19456
    ds_read_b64_tr_b16 v[120:121], v49 offset:19456
    ds_read_b64_tr_b16 v[128:129], v46 offset:20480
    ds_read_b64_tr_b16 v[136:137], v47 offset:20480
    ds_read_b64_tr_b16 v[144:145], v48 offset:20480
    ds_read_b64_tr_b16 v[152:153], v49 offset:20480
    s_cmp_eq_u32 s9, 3
    s_cbranch_scc1 Lcntok_64
    s_waitcnt vmcnt(12)
    s_mov_b32 s48, 0
Lcnt_63:
    v_cmp_ne_u32 vcc, s62, v6
    s_cbranch_vccz Lcntok_64
    s_sleep 8
    buffer_load_dword v6, v2, s[20:23], s34 offen sc1
    s_add_u32 s48, s48, 1
    s_waitcnt vmcnt(0)
    s_cmp_lt_u32 s48, s47
    s_cbranch_scc1 Lcnt_63
    s_mov_b32 s47, 0
Lcntok_64:
    s_branch Lr_7
Lx_71:
    s_add_u32 s29, s28, 32768
    buffer_load_dword v20, v54, s[20:23], s29 offen offset:0 sc1
    buffer_load_dword v21, v54, s[20:23], s29 offen offset:256 sc1
    buffer_load_dword v22, v54, s[20:23], s29 offen offset:512 sc1
    buffer_load_dword v23, v54, s[20:23], s29 offen offset:768 sc1
    buffer_load_dword v24, v54, s[20:23], s29 offen offset:1024 sc1
    buffer_load_dword v25, v54, s[20:23], s29 offen offset:1280 sc1
    buffer_load_dword v26, v54, s[20:23], s29 offen offset:1536 sc1
    buffer_load_dword v27, v54, s[20:23], s29 offen offset:1792 sc1
    buffer_load_dword v28, v55, s[20:23], s28 offen offset:12 sc1
    s_waitcnt vmcnt(19)
    s_add_u32 m0, s57, 6144
    s_add_u32 s35, s11, 18432
    buffer_load_dwordx4 v45, s[16:19], s35 offen nt lds
    s_add_u32 m0, s57, 7168
    s_add_u32 s35, s11, 18560
    buffer_load_dwordx4 v45, s[16:19], s35 offen nt lds
    s_add_u32 m0, s57, 8192
    s_add_u32 s35, s11, 18688
    buffer_load_dwordx4 v45, s[16:19], s35 offen nt lds
    s_add_u32 m0, s57, 9216
    s_add_u32 s35, s11, 21504
    buffer_load_dwordx4 v45, s[16:19], s35 offen nt lds
    s_add_u32 m0, s57, 10240
    s_add_u32 s35, s11, 21632
    buffer_load_dwordx4 v45, s[16:19], s35 offen nt lds
    s_add_u32 m0, s57, 11264
    s_add_u32 s35, s11, 21760
    buffer_load_dwordx4 v45, s[16:19], s35 offen nt lds
    s_waitcnt lgkmcnt(0)
    ds_read_b64_tr_b16 v[66:67], v46 offset:24576
    ds_read_b64_tr_b16 v[74:75], v47 offset:24576
    ds_read_b64_tr_b16 v[82:83], v48 offset:24576
    ds_read_b64_tr_b16 v[90:91], v49 offset:24576
    ds_read_b64_tr_b16 v[98:99], v46 offset:25600
    ds_read_b64_tr_b16 v[106:107], v47 offset:25600
    ds_read_b64_tr_b16 v[114:115], v48 offset:25600
    ds_read_b64_tr_b16 v[122:123], v49 offset:25600
    ds_read_b64_tr_b16 v[130:131], v46 offset:26624
    ds_read_b64_tr_b16 v[138:139], v47 offset:26624
    ds_read_b64_tr_b16 v[146:147], v48 offset:26624
    ds_read_b64_tr_b16 v[154:155], v49 offset:26624
    s_add_u32 m0, s57, 12288
    s_add_u32 s35, s11, 24576
    buffer_load_dwordx4 v45, s[16:19], s35 offen nt lds
    s_add_u32 m0, s57, 13312
    s_add_u32 s35, s11, 24704
    buffer_load_dwordx4 v45, s[16:19], s35 offen nt lds
    s_add_u32 m0, s57, 14336
    s_add_u32 s35, s11, 24832
    buffer_load_dwordx4 v45, s[16:19], s35 offen nt lds
    s_add_u32 m0, s57, 15360
    s_add_u32 s35, s11, 27648
    buffer_load_dwordx4 v45, s[16:19], s35 offen nt lds
    s_add_u32 m0, s57, 16384
    s_add_u32 s35, s11, 27776
    buffer_load_dwordx4 v45, s[16:19], s35 offen nt lds
    s_add_u32 m0, s57, 17408
    s_add_u32 s35, s11, 27904
    buffer_load_dwordx4 v45, s[16:19], s35 offen nt lds
    s_waitcnt vmcnt(12)
    v_pk_add_f32 v[20:21], v[20:21], v[22:23]
    v_pk_add_f32 v[24:25], v[24:25], v[26:27]
    v_pk_add_f32 v[20:21], v[20:21], v[24:25]
    v_add_f32 v20, v20, v21
    v_mul_f32 v61, 986500301, v20
    s_getreg_b32 s54, hwreg(HW_REG_XCC_ID, 0, 4)
    v_cmp_ne_u32 vcc, s54, v28
    v_mov_b32 v29, 162880
    s_cmp_eq_u64 vcc, 0
    s_cselect_b32 s54, 1, 0
    v_mov_b32 v28, s54
    ds_write_b32 v29, v28 offset:8
    v_mov_b64 v[20:21], 0
    v_mov_b64 v[24:25], 0
    v_mov_b64 v[28:29], 0
    v_mov_b64 v[32:33], 0
    v_mov_b64 v[36:37], 0
    v_mov_b64 v[40:41], 0
    v_mov_b64 v[44:45], 0
    v_mov_b64 v[48:49], 0
    s_branch Lc_67
Lc_67:
    v_add_f32 v12, v12, v13
    v_add_f32 v12, v12, v14
    v_add_f32 v16, v16, v17
    v_add_f32 v16, v16, v18
    v_add_f32_dpp v12, v12, v12 quad_perm:[1,0,3,2] row_mask:0xf bank_mask:0xf
    s_nop 1
    v_add_f32_dpp v12, v12, v12 quad_perm:[2,3,0,1] row_mask:0xf bank_mask:0xf
    s_nop 1
    v_add_f32_dpp v12, v12, v12 row_half_mirror row_mask:0xf bank_mask:0xf
    s_branch Lc2_72
Lcold_69:
    s_cmp_ge_u32 s53, 40
    s_cbranch_scc1 Lex_73
    s_waitcnt lgkmcnt(0)
    buffer_load_dwordx3 v[12:14], v55, s[20:23], s28 offen sc1
    buffer_load_dwordx3 v[16:18], v55, s[20:23], s28 offen offset:16 sc1
    buffer_load_dword v4, v54, s[20:23], s28 offen offset:0 sc1
    buffer_load_dword v5, v54, s[20:23], s28 offen offset:256 sc1
    buffer_load_dword v6, v54, s[20:23], s28 offen offset:512 sc1
    buffer_load_dword v7, v54, s[20:23], s28 offen offset:768 sc1
    buffer_load_dword v8, v54, s[20:23], s28 offen offset:1024 sc1
    buffer_load_dword v9, v54, s[20:23], s28 offen offset:1280 sc1
    buffer_load_dword v10, v54, s[20:23], s28 offen offset:1536 sc1
    buffer_load_dword v11, v54, s[20:23], s28 offen offset:1792 sc1
    s_add_u32 s53, s53, 1
    s_waitcnt vmcnt(0)
    s_branch Lc_67
Lex_73:
    s_cmp_gt_u32 s53, 40
    s_cbranch_scc1 Lok_68
    s_waitcnt lgkmcnt(0)
    s_mov_b32 s48, 0
Lpoll_74:
    buffer_load_dwordx3 v[12:14], v55, s[20:23], s28 offen sc1
    buffer_load_dwordx3 v[16:18], v55, s[20:23], s28 offen offset:16 sc1
    buffer_load_dword v4, v54, s[20:23], s28 offen offset:0 sc1
    buffer_load_dword v5, v54, s[20:23], s28 offen offset:256 sc1
    buffer_load_dword v6, v54, s[20:23], s28 offen offset:512 sc1
    buffer_load_dword v7, v54, s[20:23], s28 offen offset:768 sc1
    buffer_load_dword v8, v54, s[20:23], s28 offen offset:1024 sc1
    buffer_load_dword v9, v54, s[20:23], s28 offen offset:1280 sc1
    buffer_load_dword v10, v54, s[20:23], s28 offen offset:1536 sc1
    buffer_load_dword v11, v54, s[20:23], s28 offen offset:1792 sc1
    s_waitcnt vmcnt(0)
    v_max3_u32 v15, v4, v5, v6
    v_max3_u32 v15, v15, v7, v8
    v_max3_u32 v15, v15, v9, v10
    v_max3_u32 v15, v15, v11, v12
    v_max3_u32 v15, v15, v13, v14
    v_max3_u32 v15, v15, v16, v17
    v_max_u32 v15, v15, v18
    v_cmp_eq_u32 vcc, -1, v15
    s_cbranch_vccz Lgot_75
    s_add_u32 s48, s48, 1
    s_cmp_lt_u32 s48, s47
    s_cbranch_scc1 Lpoll_74
    s_mov_b32 s47, 0
Lgot_75:
    s_add_u32 s53, s53, 1
    s_branch Lc_67
Lx_65:
    s_cmp_lg_u32 s10, 0
    s_cbranch_scc1 Ls_76
    s_waitcnt vmcnt(7)
    s_add_u32 m0, s57, 6144
    s_add_u32 s35, s11, 18432
    buffer_load_dwordx4 v45, s[16:19], s35 offen nt lds
    s_waitcnt vmcnt(7)
    s_add_u32 m0, s57, 7168
    s_add_u32 s35, s11, 18560
    buffer_load_dwordx4 v45, s[16:19], s35 offen nt lds
    s_waitcnt vmcnt(7)
    s_add_u32 m0, s57, 8192
    s_add_u32 s35, s11, 18688
    buffer_load_dwordx4 v45, s[16:19], s35 offen nt lds
    s_waitcnt vmcnt(7)
    s_add_u32 m0, s57, 9216
    s_add_u32 s35, s11, 21504
    buffer_load_dwordx4 v45, s[16:19], s35 offen nt lds
    s_waitcnt vmcnt(7)
    s_add_u32 m0, s57, 10240
    s_add_u32 s35, s11, 21632
    buffer_load_dwordx4 v45, s[16:19], s35 offen nt lds
    s_waitcnt vmcnt(7)
    s_add_u32 m0, s57, 11264
    s_add_u32 s35, s11, 21760
    buffer_load_dwordx4 v45, s[16:19], s35 offen nt lds
    s_waitcnt lgkmcnt(0)
    ds_read_b64_tr_b16 v[66:67], v46 offset:24576
    ds_read_b64_tr_b16 v[74:75], v47 offset:24576
    ds_read_b64_tr_b16 v[82:83], v48 offset:24576
    ds_read_b64_tr_b16 v[90:91], v49 offset:24576
    ds_read_b64_tr_b16 v[98:99], v46 offset:25600
    ds_read_b64_tr_b16 v[106:107], v47 offset:25600
    ds_read_b64_tr_b16 v[114:115], v48 offset:25600
    ds_read_b64_tr_b16 v[122:123], v49 offset:25600
    ds_read_b64_tr_b16 v[130:131], v46 offset:26624
    ds_read_b64_tr_b16 v[138:139], v47 offset:26624
    ds_read_b64_tr_b16 v[146:147], v48 offset:26624
    ds_read_b64_tr_b16 v[154:155], v49 offset:26624
    s_waitcnt vmcnt(7)
    s_add_u32 m0, s57, 12288
    s_add_u32 s35, s11, 24576
    buffer_load_dwordx4 v45, s[16:19], s35 offen nt lds
    s_waitcnt vmcnt(7)
    s_add_u32 m0, s57, 13312
    s_add_u32 s35, s11, 24704
    buffer_load_dwordx4 v45, s[16:19], s35 offen nt lds
    s_waitcnt vmcnt(7)
    s_add_u32 m0, s57, 14336
    s_add_u32 s35, s11, 24832
    buffer_load_dwordx4 v45, s[16:19], s35 offen nt lds
    s_waitcnt vmcnt(7)
    s_add_u32 m0, s57, 15360
    s_add_u32 s35, s11, 27648
    buffer_load_dwordx4 v45, s[16:19], s35 offen nt lds
    s_waitcnt vmcnt(7)
    s_add_u32 m0, s57, 16384
    s_add_u32 s35, s11, 27776
    buffer_load_dwordx4 v45, s[16:19], s35 offen nt lds
    s_waitcnt vmcnt(7)
    s_add_u32 m0, s57, 17408
    s_add_u32 s35, s11, 27904
    buffer_load_dwordx4 v45, s[16:19], s35 offen nt lds
Ls_76:
    v_and_b32 v53, 1, v0
    v_lshlrev_b32 v53, 4, v53
    v_lshrrev_b32 v52, 4, v0
    v_lshl_add_u32 v52, v52, 5, v53
    v_add_u32 v52, 162304, v52
    v_and_b32 v53, 1, v0
    v_mul_u32_u24 v53, 0xaaaa, v53
    v_or_b32 v53, 0x4444, v53
    v_lshlrev_b32 v60, 4, v0
    s_xor_b32 s54, s10, 1
    s_mul_i32 s54, s54, 67108864
    s_add_u32 s33, s95, s54
    s_and_b32 s55, s5, 1
    s_mul_i32 s55, s55, 12224
    s_add_u32 s54, s54, s55
    s_mul_i32 s55, s9, 2944
    s_add_u32 s54, s54, s55
    s_add_u32 s32, s99, s54
    v_mov_b64 v[20:21], 0
    v_mov_b64 v[24:25], 0
    v_mov_b64 v[28:29], 0
    v_mov_b64 v[32:33], 0
    v_mov_b64 v[36:37], 0
    v_mov_b64 v[40:41], 0
    v_mov_b64 v[44:45], 0
    v_mov_b64 v[48:49], 0
    s_branch Lr_66
Lx_77:
    v_readfirstlane_b32 s3, v14
    v_bfe_u32 v12, v0, 2, 3
    v_and_b32 v2, 6, v12
    v_lshlrev_b32 v12, 7, v12
    v_lshl_add_u32 v12, v2, 4, v12
    v_and_b32 v2, 3, v0
    v_lshl_add_u32 v12, v2, 3, v12
    v_lshrrev_b32 v2, 5, v0
    v_mul_u32_u24 v2, 3072, v2
    v_add_u32 v12, v12, v2
    v_add_u32 v12, s57, v12
    v_xor_b32 v13, 32, v12
    v_xor_b32 v14, 64, v12
    v_xor_b32 v15, 96, v12
    v_lshrrev_b32 v54, 3, v0
    v_and_b32 v2, 6, v54
    v_xor_b32 v2, v2, v0
    v_and_b32 v2, 7, v2
    v_mul_u32_u24 v54, 384, v54
    v_lshl_add_u32 v54, v2, 4, v54
    s_cmp_eq_u32 s9, 3
    s_cbranch_scc1 Ls_79
    s_waitcnt vmcnt(6)
Ls_79:
    s_waitcnt vmcnt(7)
    s_add_u32 m0, s57, 18432
    s_add_u32 s35, s11, 30720
    buffer_load_dwordx4 v54, s[16:19], s35 offen nt lds
    s_cmp_eq_u32 s9, 3
    s_cbranch_scc1 Ls_80
    s_waitcnt vmcnt(6)
Ls_80:
    s_waitcnt vmcnt(7)
    s_add_u32 m0, s57, 19456
    s_add_u32 s35, s11, 30848
    buffer_load_dwordx4 v54, s[16:19], s35 offen nt lds
    s_cmp_eq_u32 s9, 3
    s_cbranch_scc1 Ls_81
    s_waitcnt vmcnt(6)
Ls_81:
    s_waitcnt vmcnt(7)
    s_add_u32 m0, s57, 20480
    s_add_u32 s35, s11, 30976
    buffer_load_dwordx4 v54, s[16:19], s35 offen nt lds
    s_cmp_eq_u32 s9, 3
    s_cbranch_scc1 Ls_82
    s_waitcnt vmcnt(6)
Ls_82:
    s_waitcnt vmcnt(7)
    s_add_u32 m0, s57, 21504
    s_add_u32 s35, s11, 33792
    buffer_load_dwordx4 v54, s[16:19], s35 offen nt lds
    s_cmp_eq_u32 s9, 3
    s_cbranch_scc1 Ls_83
    s_waitcnt vmcnt(6)
Ls_83:
    s_waitcnt vmcnt(7)
    s_add_u32 m0, s57, 22528
    s_add_u32 s35, s11, 33920
    buffer_load_dwordx4 v54, s[16:19], s35 offen nt lds
    s_cmp_eq_u32 s9, 3
    s_cbranch_scc1 Ls_84
    s_waitcnt vmcnt(6)
Ls_84:
    s_waitcnt vmcnt(7)
    s_add_u32 m0, s57, 23552
    s_add_u32 s35, s11, 34048
    buffer_load_dwordx4 v54, s[16:19], s35 offen nt lds
    s_waitcnt lgkmcnt(0)
    ds_read_b64_tr_b16 v[68:69], v12 offset:0
    ds_read_b64_tr_b16 v[76:77], v13 offset:0
    ds_read_b64_tr_b16 v[84:85], v14 offset:0
    ds_read_b64_tr_b16 v[92:93], v15 offset:0
    ds_read_b64_tr_b16 v[100:101], v12 offset:1024
    ds_read_b64_tr_b16 v[108:109], v13 offset:1024
    ds_read_b64_tr_b16 v[116:117], v14 offset:1024
    ds_read_b64_tr_b16 v[124:125], v15 offset:1024
    ds_read_b64_tr_b16 v[132:133], v12 offset:2048
    ds_read_b64_tr_b16 v[140:141], v13 offset:2048
    ds_read_b64_tr_b16 v[148:149], v14 offset:2048
    ds_read_b64_tr_b16 v[156:157], v15 offset:2048
    s_waitcnt lgkmcnt(0)
    ds_read_b64_tr_b16 v[70:71], v12 offset:6144
    ds_read_b64_tr_b16 v[78:79], v13 offset:6144
    ds_read_b64_tr_b16 v[86:87], v14 offset:6144
    ds_read_b64_tr_b16 v[94:95], v15 offset:6144
    ds_read_b64_tr_b16 v[102:103], v12 offset:7168
    ds_read_b64_tr_b16 v[110:111], v13 offset:7168
    ds_read_b64_tr_b16 v[118:119], v14 offset:7168
    ds_read_b64_tr_b16 v[126:127], v15 offset:7168
    ds_read_b64_tr_b16 v[134:135], v12 offset:8192
    ds_read_b64_tr_b16 v[142:143], v13 offset:8192
    ds_read_b64_tr_b16 v[150:151], v14 offset:8192
    ds_read_b64_tr_b16 v[158:159], v15 offset:8192
    s_waitcnt lgkmcnt(0)
    ds_read_b64_tr_b16 v[160:161], v12 offset:12288
    ds_read_b64_tr_b16 v[168:169], v13 offset:12288
    ds_read_b64_tr_b16 v[176:177], v14 offset:12288
    ds_read_b64_tr_b16 v[184:185], v15 offset:12288
    ds_read_b64_tr_b16 v[192:193], v12 offset:13312
    ds_read_b64_tr_b16 v[200:201], v13 offset:13312
    ds_read_b64_tr_b16 v[208:209], v14 offset:13312
    ds_read_b64_tr_b16 v[216:217], v15 offset:13312
    ds_read_b64_tr_b16 v[224:225], v12 offset:14336
    ds_read_b64_tr_b16 v[232:233], v13 offset:14336
    ds_read_b64_tr_b16 v[240:241], v14 offset:14336
    ds_read_b64_tr_b16 v[248:249], v15 offset:14336
    s_waitcnt lgkmcnt(0)
    s_branch Lr_78
Lx_107:
    s_waitcnt vmcnt(8)
    s_branch Lr_108
Lx_85:
    v_bfe_u32 v4, v0, 2, 3
    v_and_b32 v9, 6, v4
    v_lshlrev_b32 v4, 7, v4
    v_lshl_add_u32 v4, v9, 4, v4
    v_and_b32 v9, 3, v0
    v_lshl_add_u32 v4, v9, 3, v4
    v_lshrrev_b32 v9, 5, v0
    v_mul_u32_u24 v9, 3072, v9
    v_add_u32 v4, v4, v9
    v_add_u32 v4, s57, v4
    v_xor_b32 v5, 32, v4
    v_xor_b32 v6, 64, v4
    v_xor_b32 v7, 96, v4
    v_lshrrev_b32 v8, 3, v0
    v_and_b32 v9, 6, v8
    v_xor_b32 v9, v9, v0
    v_and_b32 v9, 7, v9
    v_mul_u32_u24 v8, 384, v8
    v_lshl_add_u32 v8, v9, 4, v8
    s_cmp_eq_u32 s9, 3
    s_cbranch_scc1 Ls_87
    s_waitcnt vmcnt(6)
Ls_87:
    s_waitcnt vmcnt(7)
    s_add_u32 m0, s57, 24576
    s_add_u32 s35, s11, 36864
    buffer_load_dwordx4 v8, s[16:19], s35 offen nt lds
    s_cmp_eq_u32 s9, 3
    s_cbranch_scc1 Ls_88
    s_waitcnt vmcnt(6)
Ls_88:
    s_waitcnt vmcnt(7)
    s_add_u32 m0, s57, 25600
    s_add_u32 s35, s11, 36992
    buffer_load_dwordx4 v8, s[16:19], s35 offen nt lds
    s_cmp_eq_u32 s9, 3
    s_cbranch_scc1 Ls_89
    s_waitcnt vmcnt(6)
Ls_89:
    s_waitcnt vmcnt(7)
    s_add_u32 m0, s57, 26624
    s_add_u32 s35, s11, 37120
    buffer_load_dwordx4 v8, s[16:19], s35 offen nt lds
    s_cmp_eq_u32 s9, 3
    s_cbranch_scc1 Ls_90
    s_waitcnt vmcnt(6)
Ls_90:
    s_waitcnt vmcnt(7)
    s_add_u32 m0, s57, 27648
    s_add_u32 s35, s11, 39936
    buffer_load_dwordx4 v8, s[16:19], s35 offen nt lds
    s_cmp_eq_u32 s9, 3
    s_cbranch_scc1 Ls_91
    s_waitcnt vmcnt(6)
Ls_91:
    s_waitcnt vmcnt(7)
    s_add_u32 m0, s57, 28672
    s_add_u32 s35, s11, 40064
    buffer_load_dwordx4 v8, s[16:19], s35 offen nt lds
    s_cmp_eq_u32 s9, 3
    s_cbranch_scc1 Ls_92
    s_waitcnt vmcnt(6)
Ls_92:
    s_waitcnt vmcnt(7)
    s_add_u32 m0, s57, 29696
    s_add_u32 s35, s11, 40192
    buffer_load_dwordx4 v8, s[16:19], s35 offen nt lds
    s_cmp_eq_u32 s9, 3
    s_cbranch_scc1 Ls_93
    s_waitcnt vmcnt(6)
Ls_93:
    s_waitcnt vmcnt(7)
    s_add_u32 m0, s57, 0
    s_add_u32 s35, s11, 43008
    buffer_load_dwordx4 v8, s[16:19], s35 offen nt lds
    s_cmp_eq_u32 s9, 3
    s_cbranch_scc1 Ls_94
    s_waitcnt vmcnt(6)
Ls_94:
    s_waitcnt vmcnt(7)
    s_add_u32 m0, s57, 1024
    s_add_u32 s35, s11, 43136
    buffer_load_dwordx4 v8, s[16:19], s35 offen nt lds
    s_cmp_eq_u32 s9, 3
    s_cbranch_scc1 Ls_95
    s_waitcnt vmcnt(6)
Ls_95:
    s_waitcnt vmcnt(7)
    s_add_u32 m0, s57, 2048
    s_add_u32 s35, s11, 43264
    buffer_load_dwordx4 v8, s[16:19], s35 offen nt lds
    s_cmp_eq_u32 s9, 3
    s_cbranch_scc1 Ls_96
    s_waitcnt vmcnt(6)
Ls_96:
    s_waitcnt vmcnt(7)
    s_add_u32 m0, s57, 3072
    s_add_u32 s35, s11, 46080
    buffer_load_dwordx4 v8, s[16:19], s35 offen nt lds
    s_cmp_eq_u32 s9, 3
    s_cbranch_scc1 Ls_97
    s_waitcnt vmcnt(6)
Ls_97:
    s_waitcnt vmcnt(7)
    s_add_u32 m0, s57, 4096
    s_add_u32 s35, s11, 46208
    buffer_load_dwordx4 v8, s[16:19], s35 offen nt lds
    s_cmp_eq_u32 s9, 3
    s_cbranch_scc1 Ls_98
    s_waitcnt vmcnt(6)
Ls_98:
    s_waitcnt vmcnt(7)
    s_add_u32 m0, s57, 5120
    s_add_u32 s35, s11, 46336
    buffer_load_dwordx4 v8, s[16:19], s35 offen nt lds
    s_waitcnt lgkmcnt(0)
    ds_read_b64_tr_b16 v[162:163], v4 offset:18432
    ds_read_b64_tr_b16 v[170:171], v5 offset:18432
    ds_read_b64_tr_b16 v[178:179], v6 offset:18432
    ds_read_b64_tr_b16 v[186:187], v7 offset:18432
    ds_read_b64_tr_b16 v[194:195], v4 offset:19456
    ds_read_b64_tr_b16 v[202:203], v5 offset:19456
    ds_read_b64_tr_b16 v[210:211], v6 offset:19456
    ds_read_b64_tr_b16 v[218:219], v7 offset:19456
    ds_read_b64_tr_b16 v[226:227], v4 offset:20480
    ds_read_b64_tr_b16 v[234:235], v5 offset:20480
    ds_read_b64_tr_b16 v[242:243], v6 offset:20480
    ds_read_b64_tr_b16 v[250:251], v7 offset:20480
    s_cmp_lg_u32 s9, 3
    s_cbranch_scc1 Ls_99
    s_mov_b32 s31, s28
    s_cmp_eq_u32 s3, 0
    s_cbranch_scc1 Ls_100
    v_lshrrev_b32 v11, 4, v0
    v_mul_u32_u24 v11, 1792, v11
    v_lshl_add_u32 v10, v0, 4, v11
    s_lshl_b32 s55, s6, 8
    s_mul_i32 s56, s6, 224
    v_add_u32 v10, s55, v10
    v_subrev_u32 v11, s56, v10
    v_cmp_gt_u32 vcc, 48, v0
    s_sub_u32 s54, s52, 6144
    s_nop 0
    v_cndmask_b32 v10, v11, v10, vcc
    s_mov_b32 exec_hi, 0x3ffff
    s_add_u32 s28, s54, 8192
    buffer_load_dword v63, v10, s[20:23], s28 offen sc1
    s_mov_b64 exec, -1
Ls_100:
    s_mov_b32 s28, s31
Ls_99:
    s_mov_b32 s24, s72
    s_mov_b32 s25, s73
    s_mov_b32 s26, 7864320
    s_mov_b32 s27, 0x00020000
    v_mul_u32_u24 v10, 205, v0
    v_lshrrev_b32 v10, 11, v10
    v_mul_u32_u24 v11, 1120, v10
    v_lshl_add_u32 v10, v0, 4, v11
    s_mul_i32 s54, s5, 245760
    s_mul_i32 s55, s6, 160
    s_add_u32 s54, s54, s55
    s_mul_i32 s55, s9, 61440
    s_add_u32 s54, s54, s55
    s_mul_i32 s55, s9, 7680
    s_mov_b64 exec, s[42:43]
    s_add_u32 m0, s55, 0
    s_add_u32 s56, s54, 0
    buffer_load_dwordx4 v10, s[24:27], s56 offen nt lds
    s_add_u32 m0, s55, 960
    s_add_u32 s56, s54, 7680
    buffer_load_dwordx4 v10, s[24:27], s56 offen nt lds
    s_cmp_eq_u32 s9, 3
    s_cbranch_scc1 Ls_101
    s_waitcnt vmcnt(8)
Ls_101:
    s_waitcnt vmcnt(9)
    s_add_u32 m0, s55, 1920
    s_add_u32 s56, s54, 15360
    buffer_load_dwordx4 v10, s[24:27], s56 offen nt lds
    s_mov_b64 exec, -1
    s_mov_b32 s24, s72
    s_mov_b32 s25, s73
    s_mov_b32 s26, 7864320
    s_mov_b32 s27, 0x00020000
    v_mul_u32_u24 v10, 205, v0
    v_lshrrev_b32 v10, 11, v10
    v_mul_u32_u24 v11, 1120, v10
    v_lshl_add_u32 v10, v0, 4, v11
    s_mul_i32 s54, s5, 245760
    s_mul_i32 s55, s6, 160
    s_add_u32 s54, s54, s55
    s_mul_i32 s55, s9, 61440
    s_add_u32 s54, s54, s55
    s_mul_i32 s55, s9, 7680
    s_mov_b64 exec, s[42:43]
    s_cmp_eq_u32 s9, 3
    s_cbranch_scc1 Ls_102
    s_waitcnt vmcnt(8)
Ls_102:
    s_waitcnt vmcnt(9)
    s_add_u32 m0, s55, 2880
    s_add_u32 s56, s54, 23040
    buffer_load_dwordx4 v10, s[24:27], s56 offen nt lds
    s_cmp_eq_u32 s9, 3
    s_cbranch_scc1 Ls_103
    s_waitcnt vmcnt(8)
Ls_103:
    s_waitcnt vmcnt(9)
    s_add_u32 m0, s55, 3840
    s_add_u32 s56, s54, 30720
    buffer_load_dwordx4 v10, s[24:27], s56 offen nt lds
    s_cmp_eq_u32 s9, 3
    s_cbranch_scc1 Ls_104
    s_waitcnt vmcnt(8)
Ls_104:
    s_waitcnt vmcnt(9)
    s_add_u32 m0, s55, 4800
    s_add_u32 s56, s54, 38400
    buffer_load_dwordx4 v10, s[24:27], s56 offen nt lds
    s_cmp_eq_u32 s9, 3
    s_cbranch_scc1 Ls_105
    s_waitcnt vmcnt(8)
Ls_105:
    s_waitcnt vmcnt(9)
    s_add_u32 m0, s55, 5760
    s_add_u32 s56, s54, 46080
    buffer_load_dwordx4 v10, s[24:27], s56 offen nt lds
    s_cmp_eq_u32 s9, 3
    s_cbranch_scc1 Ls_106
    s_waitcnt vmcnt(8)
Ls_106:
    s_waitcnt vmcnt(9)
    s_add_u32 m0, s55, 6720
    s_add_u32 s56, s54, 53760
    buffer_load_dwordx4 v10, s[24:27], s56 offen nt lds
    s_mov_b64 exec, -1
    s_waitcnt lgkmcnt(0)
    ds_read_b64_tr_b16 v[164:165], v4 offset:24576
    ds_read_b64_tr_b16 v[172:173], v5 offset:24576
    ds_read_b64_tr_b16 v[180:181], v6 offset:24576
    ds_read_b64_tr_b16 v[188:189], v7 offset:24576
    ds_read_b64_tr_b16 v[196:197], v4 offset:25600
    ds_read_b64_tr_b16 v[204:205], v5 offset:25600
    ds_read_b64_tr_b16 v[212:213], v6 offset:25600
    ds_read_b64_tr_b16 v[220:221], v7 offset:25600
    ds_read_b64_tr_b16 v[228:229], v4 offset:26624
    ds_read_b64_tr_b16 v[236:237], v5 offset:26624
    ds_read_b64_tr_b16 v[244:245], v6 offset:26624
    ds_read_b64_tr_b16 v[252:253], v7 offset:26624
    s_cmp_eq_u32 s9, 3
    s_cbranch_scc1 Lx_107
    s_waitcnt vmcnt(8)
Lr_108:
    s_waitcnt lgkmcnt(0)
    ds_read_b64_tr_b16 v[166:167], v4 offset:0
    ds_read_b64_tr_b16 v[174:175], v5 offset:0
    ds_read_b64_tr_b16 v[182:183], v6 offset:0
    ds_read_b64_tr_b16 v[190:191], v7 offset:0
    ds_read_b64_tr_b16 v[198:199], v4 offset:1024
    ds_read_b64_tr_b16 v[206:207], v5 offset:1024
    ds_read_b64_tr_b16 v[214:215], v6 offset:1024
    ds_read_b64_tr_b16 v[222:223], v7 offset:1024
    ds_read_b64_tr_b16 v[230:231], v4 offset:2048
    ds_read_b64_tr_b16 v[238:239], v5 offset:2048
    ds_read_b64_tr_b16 v[246:247], v6 offset:2048
    ds_read_b64_tr_b16 v[254:255], v7 offset:2048
    s_waitcnt lgkmcnt(0)
    s_branch Lr_86
Lx_109:
    s_mov_b64 exec, s[40:41]
    buffer_store_dwordx2 v[2:3], v26, s[20:23], s30 offen sc1
    s_mov_b64 exec, -1
    s_waitcnt lgkmcnt(0)
    v_pk_add_f32 v[8:9], v[8:9], v[10:11]
    v_add_f32 v8, v8, v9
    buffer_store_dword v8, v26, s[20:23], s29 offen sc1
    s_branch Lr_110
Lx_111:
    s_mov_b32 s24, s78
    s_mov_b32 s25, s79
    s_mov_b32 s26, 7864320
    s_mov_b32 s27, 0x00020000
    s_mul_i32 s54, s6, 983040
    s_mul_i32 s55, s5, 384
    s_add_u32 s54, s54, s55
    v_lshrrev_b32 v12, 3, v0
    v_and_b32 v13, 6, v12
    v_xor_b32 v13, v13, v0
    v_and_b32 v13, 7, v13
    v_mul_u32_u24 v12, 12288, v12
    v_lshl_add_u32 v12, v13, 4, v12
    s_add_u32 s55, s9, 0
    s_lshl_b32 s56, s55, 10
    s_add_u32 m0, s56, 30720
    s_mul_i32 s56, s55, 43
    s_lshr_b32 s56, s56, 7
    s_mul_i32 s56, s56, 97920
    s_lshl_b32 s55, s55, 7
    s_add_u32 s56, s56, s55
    s_add_u32 s56, s56, s54
    s_cmp_eq_u32 s9, 3
    s_cbranch_scc1 Ls_113
    s_waitcnt vmcnt(8)
Ls_113:
    s_waitcnt vmcnt(9)
    buffer_load_dwordx4 v12, s[24:27], s56 offen nt lds
    s_add_u32 s55, s9, 4
    s_lshl_b32 s56, s55, 10
    s_add_u32 m0, s56, 30720
    s_mul_i32 s56, s55, 43
    s_lshr_b32 s56, s56, 7
    s_mul_i32 s56, s56, 97920
    s_lshl_b32 s55, s55, 7
    s_add_u32 s56, s56, s55
    s_add_u32 s56, s56, s54
    s_cmp_eq_u32 s9, 3
    s_cbranch_scc1 Ls_114
    s_waitcnt vmcnt(8)
Ls_114:
    s_waitcnt vmcnt(9)
    buffer_load_dwordx4 v12, s[24:27], s56 offen nt lds
    s_add_u32 s55, s9, 8
    s_lshl_b32 s56, s55, 10
    s_add_u32 m0, s56, 30720
    s_mul_i32 s56, s55, 43
    s_lshr_b32 s56, s56, 7
    s_mul_i32 s56, s56, 97920
    s_lshl_b32 s55, s55, 7
    s_add_u32 s56, s56, s55
    s_add_u32 s56, s56, s54
    s_cmp_eq_u32 s9, 3
    s_cbranch_scc1 Ls_115
    s_waitcnt vmcnt(8)
Ls_115:
    s_waitcnt vmcnt(9)
    buffer_load_dwordx4 v12, s[24:27], s56 offen nt lds
    s_add_u32 s55, s9, 12
    s_lshl_b32 s56, s55, 10
    s_add_u32 m0, s56, 30720
    s_mul_i32 s56, s55, 43
    s_lshr_b32 s56, s56, 7
    s_mul_i32 s56, s56, 97920
    s_lshl_b32 s55, s55, 7
    s_add_u32 s56, s56, s55
    s_add_u32 s56, s56, s54
    s_cmp_eq_u32 s9, 3
    s_cbranch_scc1 Ls_116
    s_waitcnt vmcnt(8)
Ls_116:
    s_waitcnt vmcnt(9)
    buffer_load_dwordx4 v12, s[24:27], s56 offen nt lds
    s_add_u32 s55, s9, 16
    s_lshl_b32 s56, s55, 10
    s_add_u32 m0, s56, 30720
    s_mul_i32 s56, s55, 43
    s_lshr_b32 s56, s56, 7
    s_mul_i32 s56, s56, 97920
    s_lshl_b32 s55, s55, 7
    s_add_u32 s56, s56, s55
    s_add_u32 s56, s56, s54
    s_cmp_eq_u32 s9, 3
    s_cbranch_scc1 Ls_117
    s_waitcnt vmcnt(8)
Ls_117:
    s_waitcnt vmcnt(9)
    buffer_load_dwordx4 v12, s[24:27], s56 offen nt lds
    s_add_u32 s55, s9, 20
    s_lshl_b32 s56, s55, 10
    s_add_u32 m0, s56, 30720
    s_mul_i32 s56, s55, 43
    s_lshr_b32 s56, s56, 7
    s_mul_i32 s56, s56, 97920
    s_lshl_b32 s55, s55, 7
    s_add_u32 s56, s56, s55
    s_add_u32 s56, s56, s54
    s_cmp_eq_u32 s9, 3
    s_cbranch_scc1 Ls_118
    s_waitcnt vmcnt(8)
Ls_118:
    s_waitcnt vmcnt(9)
    buffer_load_dwordx4 v12, s[24:27], s56 offen nt lds
    s_add_u32 s55, s9, 24
    s_lshl_b32 s56, s55, 10
    s_add_u32 m0, s56, 30720
    s_mul_i32 s56, s55, 43
    s_lshr_b32 s56, s56, 7
    s_mul_i32 s56, s56, 97920
    s_lshl_b32 s55, s55, 7
    s_add_u32 s56, s56, s55
    s_add_u32 s56, s56, s54
    s_cmp_eq_u32 s9, 3
    s_cbranch_scc1 Ls_119
    s_waitcnt vmcnt(8)
Ls_119:
    s_waitcnt vmcnt(9)
    buffer_load_dwordx4 v12, s[24:27], s56 offen nt lds
    s_and_b32 s55, s9, 1
    s_add_u32 s55, s55, 28
    s_lshl_b32 s56, s55, 10
    s_add_u32 m0, s56, 30720
    s_mul_i32 s56, s55, 43
    s_lshr_b32 s56, s56, 7
    s_mul_i32 s56, s56, 97920
    s_lshl_b32 s55, s55, 7
    s_add_u32 s56, s56, s55
    s_add_u32 s56, s56, s54
    s_waitcnt vmcnt(9)
    buffer_load_dwordx4 v12, s[24:27], s56 offen nt lds
    s_branch Lr_112
Lx_125:
    s_mov_b32 s24, s80
    s_mov_b32 s25, s81
    s_mov_b32 s26, 9437184
    s_mov_b32 s27, 0x00020000
    s_mul_i32 s54, s6, 1179648
    s_mul_i32 s55, s5, 384
    s_add_u32 s54, s54, s55
    v_lshrrev_b32 v16, 3, v0
    v_and_b32 v17, 6, v16
    v_xor_b32 v17, v17, v0
    v_and_b32 v17, 7, v17
    v_mul_u32_u24 v16, 12288, v16
    v_lshl_add_u32 v16, v17, 4, v16
    s_mul_i32 s55, s9, 294912
    s_add_u32 s54, s54, s55
    s_mul_i32 s55, s9, 9216
    s_add_u32 m0, s55, 92160
    s_add_u32 s56, s54, 0
    buffer_load_dwordx4 v16, s[24:27], s56 offen nt lds
    s_add_u32 m0, s55, 93184
    s_add_u32 s56, s54, 128
    buffer_load_dwordx4 v16, s[24:27], s56 offen nt lds
    s_add_u32 m0, s55, 94208
    s_add_u32 s56, s54, 256
    buffer_load_dwordx4 v16, s[24:27], s56 offen nt lds
    s_add_u32 m0, s55, 95232
    s_add_u32 s56, s54, 98304
    buffer_load_dwordx4 v16, s[24:27], s56 offen nt lds
    s_add_u32 m0, s55, 96256
    s_add_u32 s56, s54, 98432
    buffer_load_dwordx4 v16, s[24:27], s56 offen nt lds
    s_add_u32 m0, s55, 97280
    s_add_u32 s56, s54, 98560
    buffer_load_dwordx4 v16, s[24:27], s56 offen nt lds
    s_waitcnt vmcnt(6)
    s_branch Lc_122
Lc_122:
    v_max_f32_dpp v14, v12, v12 quad_perm:[1,0,3,2] row_mask:0xf bank_mask:0xf
    s_nop 1
    v_max_f32_dpp v14, v14, v14 quad_perm:[2,3,0,1] row_mask:0xf bank_mask:0xf
    s_nop 1
    v_max_f32_dpp v14, v14, v14 row_half_mirror row_mask:0xf bank_mask:0xf
    v_sub_f32 v12, v12, v14
    v_exp_f32 v12, v12
    s_nop 0
    v_mul_f32 v13, v13, v12
    s_branch Lc2_126
Lcold_124:
    s_cmp_ge_u32 s53, 40
    s_cbranch_scc1 Lex_127
    s_waitcnt lgkmcnt(0)
    buffer_load_dwordx2 v[12:13], v27, s[20:23], s28 offen sc1
    buffer_load_dword v4, v26, s[20:23], s28 offen offset:0 sc1
    buffer_load_dword v5, v26, s[20:23], s28 offen offset:256 sc1
    buffer_load_dword v6, v26, s[20:23], s28 offen offset:512 sc1
    buffer_load_dword v7, v26, s[20:23], s28 offen offset:768 sc1
    buffer_load_dword v8, v26, s[20:23], s28 offen offset:1024 sc1
    buffer_load_dword v9, v26, s[20:23], s28 offen offset:1280 sc1
    buffer_load_dword v10, v26, s[20:23], s28 offen offset:1536 sc1
    buffer_load_dword v11, v26, s[20:23], s28 offen offset:1792 sc1
    s_add_u32 s53, s53, 1
    s_waitcnt vmcnt(0)
    s_branch Lc_122
Lex_127:
    s_cmp_gt_u32 s53, 40
    s_cbranch_scc1 Lok_123
    s_waitcnt lgkmcnt(0)
    s_mov_b32 s48, 0
Lpoll_128:
    buffer_load_dwordx2 v[12:13], v27, s[20:23], s28 offen sc1
    buffer_load_dword v4, v26, s[20:23], s28 offen offset:0 sc1
    buffer_load_dword v5, v26, s[20:23], s28 offen offset:256 sc1
    buffer_load_dword v6, v26, s[20:23], s28 offen offset:512 sc1
    buffer_load_dword v7, v26, s[20:23], s28 offen offset:768 sc1
    buffer_load_dword v8, v26, s[20:23], s28 offen offset:1024 sc1
    buffer_load_dword v9, v26, s[20:23], s28 offen offset:1280 sc1
    buffer_load_dword v10, v26, s[20:23], s28 offen offset:1536 sc1
    buffer_load_dword v11, v26, s[20:23], s28 offen offset:1792 sc1
    s_waitcnt vmcnt(0)
    v_max3_u32 v15, v4, v5, v6
    v_max3_u32 v15, v15, v7, v8
    v_max3_u32 v15, v15, v9, v10
    v_max3_u32 v15, v15, v11, v12
    v_max_u32 v15, v15, v13
    v_cmp_eq_u32 vcc, -1, v15
    s_cbranch_vccz Lgot_129
    s_add_u32 s48, s48, 1
    s_cmp_lt_u32 s48, s47
    s_cbranch_scc1 Lpoll_128
    s_mov_b32 s47, 0
Lgot_129:
    s_add_u32 s53, s53, 1
    s_branch Lc_122
Lx_130:
    ds_read_b64_tr_b16 v[30:31], v28 offset:0
    ds_read_b64_tr_b16 v[32:33], v28 offset:2560
    ds_read_b64_tr_b16 v[34:35], v28 offset:5120
    ds_read_b64_tr_b16 v[36:37], v28 offset:7680
    ds_read_b64_tr_b16 v[38:39], v28 offset:10240
    ds_read_b64_tr_b16 v[40:41], v28 offset:12800
    ds_read_b64_tr_b16 v[42:43], v28 offset:15360
    ds_read_b64_tr_b16 v[44:45], v28 offset:17920
    ds_read_b64_tr_b16 v[46:47], v28 offset:20480
    ds_read_b64_tr_b16 v[48:49], v28 offset:23040
    ds_read_b64_tr_b16 v[50:51], v28 offset:25600
    ds_read_b64_tr_b16 v[52:53], v28 offset:28160
    s_waitcnt lgkmcnt(0)
    s_branch Lr_131
Lx_135:
    ds_read_b64_tr_b16 v[30:31], v28 offset:0
    ds_read_b64_tr_b16 v[32:33], v28 offset:2560
    ds_read_b64_tr_b16 v[34:35], v28 offset:5120
    ds_read_b64_tr_b16 v[36:37], v28 offset:7680
    ds_read_b64_tr_b16 v[38:39], v28 offset:10240
    ds_read_b64_tr_b16 v[40:41], v28 offset:12800
    ds_read_b64_tr_b16 v[42:43], v28 offset:15360
    ds_read_b64_tr_b16 v[44:45], v28 offset:17920
    ds_read_b64_tr_b16 v[46:47], v28 offset:20480
    ds_read_b64_tr_b16 v[48:49], v28 offset:23040
    ds_read_b64_tr_b16 v[50:51], v28 offset:25600
    ds_read_b64_tr_b16 v[52:53], v28 offset:28160
    ds_read_b64_tr_b16 v[14:15], v54 offset:32
    ds_read_b64_tr_b16 v[16:17], v54 offset:2592
    ds_read_b64_tr_b16 v[18:19], v54 offset:5152
    ds_read_b64_tr_b16 v[20:21], v54 offset:7712
    ds_read_b64_tr_b16 v[22:23], v54 offset:10272
    ds_read_b64_tr_b16 v[24:25], v54 offset:12832
    ds_read_b64_tr_b16 v[26:27], v54 offset:15392
    ds_read_b64_tr_b16 v[28:29], v54 offset:17952
    s_waitcnt lgkmcnt(0)
    s_branch Lr_136
Lx_120:
    s_cmp_lg_u32 s10, 0
    s_cbranch_scc1 Ls_132
    s_mov_b32 s24, s80
    s_mov_b32 s25, s81
    s_mov_b32 s26, 9437184
    s_mov_b32 s27, 0x00020000
    s_mul_i32 s54, s6, 1179648
    s_mul_i32 s55, s5, 384
    s_add_u32 s54, s54, s55
    v_lshrrev_b32 v1, 3, v0
    v_and_b32 v2, 6, v1
    v_xor_b32 v2, v2, v0
    v_and_b32 v2, 7, v2
    v_mul_u32_u24 v1, 12288, v1
    v_lshl_add_u32 v1, v2, 4, v1
    s_mul_i32 s55, s9, 294912
    s_add_u32 s54, s54, s55
    s_mul_i32 s55, s9, 9216
    s_add_u32 m0, s55, 92160
    s_add_u32 s56, s54, 0
    buffer_load_dwordx4 v1, s[24:27], s56 offen nt lds
    s_add_u32 m0, s55, 93184
    s_add_u32 s56, s54, 128
    buffer_load_dwordx4 v1, s[24:27], s56 offen nt lds
    s_add_u32 m0, s55, 94208
    s_add_u32 s56, s54, 256
    buffer_load_dwordx4 v1, s[24:27], s56 offen nt lds
    s_add_u32 m0, s55, 95232
    s_add_u32 s56, s54, 98304
    buffer_load_dwordx4 v1, s[24:27], s56 offen nt lds
    s_add_u32 m0, s55, 96256
    s_add_u32 s56, s54, 98432
    buffer_load_dwordx4 v1, s[24:27], s56 offen nt lds
    s_add_u32 m0, s55, 97280
    s_add_u32 s56, s54, 98560
    buffer_load_dwordx4 v1, s[24:27], s56 offen nt lds
    s_waitcnt vmcnt(6)
Ls_132:
    v_lshrrev_b32 v28, 2, v0
    v_mul_u32_u24 v28, 160, v28
    v_and_b32 v29, 3, v0
    v_lshl_add_u32 v28, v29, 3, v28
    s_lshl_b32 s54, s9, 5
    s_add_u32 s54, s54, 0
    v_add_u32 v28, s54, v28
    ds_read_b64_tr_b16 v[30:31], v28 offset:0
    ds_read_b64_tr_b16 v[32:33], v28 offset:2560
    ds_read_b64_tr_b16 v[34:35], v28 offset:5120
    ds_read_b64_tr_b16 v[36:37], v28 offset:7680
    ds_read_b64_tr_b16 v[38:39], v28 offset:10240
    ds_read_b64_tr_b16 v[40:41], v28 offset:12800
    ds_read_b64_tr_b16 v[42:43], v28 offset:15360
    ds_read_b64_tr_b16 v[44:45], v28 offset:17920
    ds_read_b64_tr_b16 v[46:47], v28 offset:20480
    ds_read_b64_tr_b16 v[48:49], v28 offset:23040
    ds_read_b64_tr_b16 v[50:51], v28 offset:25600
    ds_read_b64_tr_b16 v[52:53], v28 offset:28160
    v_and_b32 v29, 1, v0
    v_lshlrev_b32 v29, 4, v29
    v_lshrrev_b32 v55, 4, v0
    v_lshl_add_u32 v55, v55, 5, v29
    v_add_u32 v55, 162304, v55
    v_and_b32 v29, 1, v0
    v_mul_u32_u24 v29, 0xaaaa, v29
    v_or_b32 v29, 0x4444, v29
    v_mov_b64 v[22:23], 0
    s_cmp_eq_u32 s10, 0
    s_cbranch_scc1 Ls_133
    s_waitcnt vmcnt(2)
Ls_133:
    v_mov_b32 v1, v29
    v_mov_b32 v54, v28
    v_mov_b64 v[2:3], 0
    v_mov_b64 v[60:61], 0
    s_cmp_eq_u32 s10, 0
    s_cbranch_scc1 Ls_134
    ds_read_b64_tr_b16 v[14:15], v54 offset:32
    ds_read_b64_tr_b16 v[16:17], v54 offset:2592
    ds_read_b64_tr_b16 v[18:19], v54 offset:5152
    ds_read_b64_tr_b16 v[20:21], v54 offset:7712
    ds_read_b64_tr_b16 v[22:23], v54 offset:10272
    ds_read_b64_tr_b16 v[24:25], v54 offset:12832
    ds_read_b64_tr_b16 v[26:27], v54 offset:15392
    ds_read_b64_tr_b16 v[28:29], v54 offset:17952
Ls_134:
    s_waitcnt lgkmcnt(0)
    s_barrier
    ds_read_b128 v[6:9], v55
    ds_read_b128 v[10:13], v55 offset:128
    ds_read_b128 a[236:239], v55 offset:256
    s_cmp_eq_u32 s10, 0
    s_cbranch_scc1 Lx_135
Lr_136:
    s_waitcnt lgkmcnt(2)
    v_smfmac_f32_16x16x64_bf16 v[60:63], v[6:9], v[30:37], v1
    ds_read_b64_tr_b16 v[30:31], v54 offset:20512
    ds_read_b64_tr_b16 v[32:33], v54 offset:23072
    ds_read_b64_tr_b16 v[34:35], v54 offset:25632
    ds_read_b64_tr_b16 v[36:37], v54 offset:28192
    v_smfmac_f32_16x16x64_bf16 v[2:5], v[6:9], v[14:21], v1
    s_waitcnt lgkmcnt(5)
    v_smfmac_f32_16x16x64_bf16 v[60:63], v[10:13], v[38:45], v1
    v_lshrrev_b32 v6, 4, v0
    v_mul_u32_u24 v6, 3968, v6
    v_smfmac_f32_16x16x64_bf16 v[2:5], v[10:13], v[22:29], v1
    v_lshl_add_u32 v6, v0, 2, v6
    s_waitcnt lgkmcnt(4)
    v_smfmac_f32_16x16x64_bf16 v[60:63], a[236:239], v[46:53], v1
    s_waitcnt lgkmcnt(0)
    v_smfmac_f32_16x16x64_bf16 v[2:5], a[236:239], v[30:37], v1
    s_mov_b64 exec, s[50:51]
    s_nop 4
    v_add_f32_dpp v7, v60, v61 quad_perm:[0,1,2,3] row_mask:0x1 bank_mask:0xf
    s_nop 0
    v_add_f32_dpp v7, v2, v3 quad_perm:[0,1,2,3] row_mask:0x2 bank_mask:0xf
    buffer_store_dword v7, v6, s[20:23], s45 offen sc1
    s_mov_b64 exec, -1
    s_cmp_lg_u32 s10, 0
    s_cbranch_scc1 Ls_137
    v_mov_b32 v8, -1
    v_mov_b32 v9, -1
    v_mov_b32 v10, -1
    v_mov_b32 v11, -1
    v_lshlrev_b32 v12, 4, v0
    s_add_u32 s29, s95, 4294961152
    s_add_u32 s30, s29, 4096
    buffer_store_dwordx4 v[8:11], v12, s[20:23], s29 offen offset:0 sc1
    buffer_store_dwordx4 v[8:11], v12, s[20:23], s29 offen offset:1024 sc1
    buffer_store_dwordx4 v[8:11], v12, s[20:23], s29 offen offset:2048 sc1
    buffer_store_dwordx4 v[8:11], v12, s[20:23], s29 offen offset:3072 sc1
    buffer_store_dwordx4 v[8:11], v12, s[20:23], s30 offen offset:0 sc1
    buffer_store_dwordx4 v[8:11], v12, s[20:23], s30 offen offset:1024 sc1
    buffer_store_dwordx4 v[8:11], v12, s[20:23], s30 offen offset:2048 sc1
    buffer_store_dwordx4 v[8:11], v12, s[20:23], s30 offen offset:3072 sc1
    s_and_b32 s29, s5, 1
    s_mul_i32 s29, s29, 12224
    s_add_u32 s28, s99, s29
    s_add_u32 s28, s28, 4294966912
    buffer_store_dwordx4 v[8:11], v12, s[20:23], s28 offen offset:0 sc1
    buffer_store_dwordx4 v[8:11], v12, s[20:23], s28 offen offset:1024 sc1
    buffer_store_dwordx4 v[8:11], v12, s[20:23], s28 offen offset:2048 sc1
    buffer_store_dwordx4 v[8:11], v12, s[20:23], s28 offen offset:3072 sc1
    s_add_u32 s28, s28, 4096
    buffer_store_dwordx4 v[8:11], v12, s[20:23], s28 offen offset:0 sc1
    buffer_store_dwordx4 v[8:11], v12, s[20:23], s28 offen offset:1024 sc1
    buffer_store_dwordx4 v[8:11], v12, s[20:23], s28 offen offset:2048 sc1
    buffer_store_dwordx4 v[8:11], v12, s[20:23], s28 offen offset:3072 sc1
    s_add_u32 s28, s28, 4096
    buffer_store_dwordx4 v[8:11], v12, s[20:23], s28 offen offset:0 sc1
    buffer_store_dwordx4 v[8:11], v12, s[20:23], s28 offen offset:1024 sc1
    buffer_store_dwordx4 v[8:11], v12, s[20:23], s28 offen offset:2048 sc1
    buffer_store_dwordx4 v[8:11], v12, s[20:23], s28 offen offset:3072 sc1
    s_add_u32 s28, s28, 4096
Ls_137:
    s_cmp_eq_u32 s10, 0
    s_cbranch_scc1 Ls_138
    s_cmp_eq_u32 s3, 0
    s_cbranch_scc1 Ls_139
    v_lshrrev_b32 v14, 4, v0
    v_mul_u32_u24 v14, 1792, v14
    v_lshl_add_u32 v13, v0, 4, v14
    s_lshl_b32 s55, s6, 8
    s_mul_i32 s56, s6, 224
    v_add_u32 v13, s55, v13
    v_subrev_u32 v14, s56, v13
    v_cmp_gt_u32 vcc, 48, v0
    s_sub_u32 s54, s52, 6144
    s_nop 0
    v_cndmask_b32 v13, v14, v13, vcc
    s_mov_b32 exec_hi, 0x3ffff
    s_add_u32 s28, s54, 16384
    buffer_load_dword v63, v13, s[20:23], s28 offen sc1
    s_add_u32 s28, s54, 24576
    buffer_load_dword v63, v13, s[20:23], s28 offen sc1
    s_mov_b64 exec, -1
    s_sub_u32 s28, s95, 6144
    v_lshlrev_b32 v13, 7, v0
    buffer_load_dword v63, v13, s[20:23], s28 offen sc1
Ls_139:
Ls_138:
    s_branch Lr_121
Lx_140:
    s_mov_b32 s24, s80
    s_mov_b32 s25, s81
    s_mov_b32 s26, 9437184
    s_mov_b32 s27, 0x00020000
    s_mul_i32 s54, s6, 1179648
    s_mul_i32 s55, s5, 384
    s_add_u32 s54, s54, s55
    v_lshrrev_b32 v14, 3, v0
    v_and_b32 v15, 6, v14
    v_xor_b32 v15, v15, v0
    v_and_b32 v15, 7, v15
    v_mul_u32_u24 v14, 12288, v14
    v_lshl_add_u32 v14, v15, 4, v14
    s_mul_i32 s55, s9, 294912
    s_add_u32 s54, s54, s55
    s_mul_i32 s55, s9, 9216
    s_waitcnt vmcnt(20)
    s_add_u32 m0, s55, 98304
    s_add_u32 s56, s54, 196608
    buffer_load_dwordx4 v14, s[24:27], s56 offen nt lds
    s_add_u32 m0, s55, 99328
    s_add_u32 s56, s54, 196736
    buffer_load_dwordx4 v14, s[24:27], s56 offen nt lds
    s_cmp_eq_u32 s9, 3
    s_cbranch_scc1 Ls_142
    s_waitcnt vmcnt(8)
Ls_142:
    s_add_u32 m0, s55, 100352
    s_add_u32 s56, s54, 196864
    buffer_load_dwordx4 v14, s[24:27], s56 offen nt lds
    s_mov_b32 s24, s76
    s_mov_b32 s25, s77
    s_mov_b32 s26, 6291456
    s_mov_b32 s27, 0x00020000
    s_mul_i32 s54, s7, 98304
    s_mul_i32 s55, s8, 384
    s_add_u32 s54, s54, s55
    v_lshrrev_b32 v14, 3, v0
    v_and_b32 v15, 6, v14
    v_xor_b32 v15, v15, v0
    v_and_b32 v15, 7, v15
    v_mul_u32_u24 v14, 1536, v14
    v_lshl_add_u32 v14, v15, 4, v14
    s_mul_i32 s55, s9, 24576
    s_add_u32 s54, s54, s55
    s_mul_i32 s55, s9, 6144
    s_cmp_eq_u32 s9, 3
    s_cbranch_scc1 Ls_143
    s_waitcnt vmcnt(8)
Ls_143:
    s_add_u32 m0, s55, 129024
    s_add_u32 s56, s54, 0
    buffer_load_dwordx4 v14, s[24:27], s56 offen nt lds
    s_cmp_eq_u32 s9, 3
    s_cbranch_scc1 Ls_144
    s_waitcnt vmcnt(8)
Ls_144:
    s_add_u32 m0, s55, 130048
    s_add_u32 s56, s54, 128
    buffer_load_dwordx4 v14, s[24:27], s56 offen nt lds
    s_cmp_eq_u32 s9, 3
    s_cbranch_scc1 Ls_145
    s_waitcnt vmcnt(8)
Ls_145:
    s_add_u32 m0, s55, 131072
    s_add_u32 s56, s54, 256
    buffer_load_dwordx4 v14, s[24:27], s56 offen nt lds
    s_cmp_eq_u32 s9, 3
    s_cbranch_scc1 Ls_146
    s_waitcnt vmcnt(8)
Ls_146:
    s_add_u32 m0, s55, 132096
    s_add_u32 s56, s54, 12288
    buffer_load_dwordx4 v14, s[24:27], s56 offen nt lds
    s_cmp_eq_u32 s9, 3
    s_cbranch_scc1 Ls_147
    s_waitcnt vmcnt(8)
Ls_147:
    s_add_u32 m0, s55, 133120
    s_add_u32 s56, s54, 12416
    buffer_load_dwordx4 v14, s[24:27], s56 offen nt lds
    s_add_u32 m0, s55, 134144
    s_add_u32 s56, s54, 12544
    buffer_load_dwordx4 v14, s[24:27], s56 offen nt lds
    s_mov_b32 s24, s84
    s_mov_b32 s25, s85
    s_mov_b32 s26, 7864320
    s_mov_b32 s27, 0x00020000
    v_mul_u32_u24 v14, 205, v0
    v_lshrrev_b32 v14, 11, v14
    v_mul_u32_u24 v15, 1120, v14
    v_lshl_add_u32 v14, v0, 4, v15
    s_mul_i32 s54, s5, 245760
    s_mul_i32 s55, s6, 160
    s_add_u32 s54, s54, s55
    s_mul_i32 s55, s9, 61440
    s_add_u32 s54, s54, s55
    s_mul_i32 s55, s9, 7680
    s_mov_b64 exec, s[42:43]
    s_add_u32 m0, s55, 61440
    s_add_u32 s56, s54, 0
    buffer_load_dwordx4 v14, s[24:27], s56 offen nt lds
    s_add_u32 m0, s55, 62400
    s_add_u32 s56, s54, 7680
    buffer_load_dwordx4 v14, s[24:27], s56 offen nt lds
    s_mov_b64 exec, -1
    s_branch Lr_141
Lx_153:
    s_mov_b32 s24, s84
    s_mov_b32 s25, s85
    s_mov_b32 s26, 7864320
    s_mov_b32 s27, 0x00020000
    v_mul_u32_u24 v3, 205, v0
    v_lshrrev_b32 v3, 11, v3
    v_mul_u32_u24 v23, 1120, v3
    v_lshl_add_u32 v3, v0, 4, v23
    s_mul_i32 s54, s5, 245760
    s_mul_i32 s55, s6, 160
    s_add_u32 s54, s54, s55
    s_mul_i32 s55, s9, 61440
    s_add_u32 s54, s54, s55
    s_mul_i32 s55, s9, 7680
    s_mov_b64 exec, s[42:43]
    s_add_u32 m0, s55, 63360
    s_add_u32 s56, s54, 15360
    buffer_load_dwordx4 v3, s[24:27], s56 offen nt lds
    s_add_u32 m0, s55, 64320
    s_add_u32 s56, s54, 23040
    buffer_load_dwordx4 v3, s[24:27], s56 offen nt lds
    s_add_u32 m0, s55, 65280
    s_add_u32 s56, s54, 30720
    buffer_load_dwordx4 v3, s[24:27], s56 offen nt lds
    s_add_u32 m0, s55, 66240
    s_add_u32 s56, s54, 38400
    buffer_load_dwordx4 v3, s[24:27], s56 offen nt lds
    s_add_u32 m0, s55, 67200
    s_add_u32 s56, s54, 46080
    buffer_load_dwordx4 v3, s[24:27], s56 offen nt lds
    s_add_u32 m0, s55, 68160
    s_add_u32 s56, s54, 53760
    buffer_load_dwordx4 v3, s[24:27], s56 offen nt lds
    s_mov_b64 exec, -1
    s_waitcnt vmcnt(6)
    s_branch Lc_150
Lcold_152:
    s_cmp_ge_u32 s53, 40
    s_cbranch_scc1 Lex_154
    s_waitcnt lgkmcnt(0)
    buffer_load_dwordx4 v[6:9], v54, s[20:23], s46 offen offset:0 sc1
    buffer_load_dwordx4 v[10:13], v54, s[20:23], s46 offen offset:1024 sc1
    buffer_load_dwordx4 v[14:17], v54, s[20:23], s46 offen offset:2048 sc1
    buffer_load_dwordx4 v[18:21], v54, s[20:23], s46 offen offset:3072 sc1
    s_add_u32 s53, s53, 1
    s_waitcnt vmcnt(0)
    s_branch Lc_150
Lex_154:
    s_cmp_gt_u32 s53, 40
    s_cbranch_scc1 Lok_151
    s_waitcnt lgkmcnt(0)
    s_mov_b32 s48, 0
Lpoll_155:
    buffer_load_dwordx4 v[6:9], v54, s[20:23], s46 offen offset:0 sc1
    buffer_load_dwordx4 v[10:13], v54, s[20:23], s46 offen offset:1024 sc1
    buffer_load_dwordx4 v[14:17], v54, s[20:23], s46 offen offset:2048 sc1
    buffer_load_dwordx4 v[18:21], v54, s[20:23], s46 offen offset:3072 sc1
    s_waitcnt vmcnt(0)
    v_max3_u32 v3, v6, v7, v8
    v_max3_u32 v3, v3, v9, v10
    v_max3_u32 v3, v3, v11, v12
    v_max3_u32 v3, v3, v13, v14
    v_max3_u32 v3, v3, v15, v16
    v_max3_u32 v3, v3, v17, v18
    v_max3_u32 v3, v3, v19, v20
    v_max_u32 v3, v3, v21
    v_cmp_eq_u32 vcc, -1, v3
    s_cbranch_vccz Lgot_156
    s_add_u32 s48, s48, 1
    s_cmp_lt_u32 s48, s47
    s_cbranch_scc1 Lpoll_155
    s_mov_b32 s47, 0
Lgot_156:
    s_add_u32 s53, s53, 1
    s_branch Lc_150
Lx_157:
    s_cmp_eq_u32 s3, 0
    s_cbranch_scc1 Ls_159
    v_lshrrev_b32 v14, 4, v0
    v_mul_u32_u24 v14, 1792, v14
    v_lshl_add_u32 v13, v0, 4, v14
    s_lshl_b32 s55, s6, 8
    s_mul_i32 s56, s6, 224
    v_add_u32 v13, s55, v13
    v_subrev_u32 v14, s56, v13
    v_cmp_gt_u32 vcc, 48, v0
    s_sub_u32 s54, s52, 6144
    s_nop 0
    v_cndmask_b32 v13, v14, v13, vcc
    s_mov_b32 exec_hi, 0x3ffff
    s_add_u32 s28, s54, 16384
    buffer_load_dword v63, v13, s[20:23], s28 offen sc1
    s_add_u32 s28, s54, 40960
    buffer_load_dword v63, v13, s[20:23], s28 offen sc1
    s_mov_b64 exec, -1
    s_sub_u32 s28, s95, 6144
    v_lshlrev_b32 v13, 7, v0
    buffer_load_dword v63, v13, s[20:23], s28 offen sc1
Ls_159:
    s_mov_b32 s24, s84
    s_mov_b32 s25, s85
    s_mov_b32 s26, 7864320
    s_mov_b32 s27, 0x00020000
    v_mul_u32_u24 v6, 205, v0
    v_lshrrev_b32 v6, 11, v6
    v_mul_u32_u24 v7, 1120, v6
    v_lshl_add_u32 v6, v0, 4, v7
    s_mul_i32 s54, s5, 245760
    s_mul_i32 s55, s6, 160
    s_add_u32 s54, s54, s55
    s_mul_i32 s55, s9, 61440
    s_add_u32 s54, s54, s55
    s_mul_i32 s55, s9, 7680
    s_mov_b64 exec, s[42:43]
    s_add_u32 m0, s55, 63360
    s_add_u32 s56, s54, 15360
    buffer_load_dwordx4 v6, s[24:27], s56 offen nt lds
    s_add_u32 m0, s55, 64320
    s_add_u32 s56, s54, 23040
    buffer_load_dwordx4 v6, s[24:27], s56 offen nt lds
    s_add_u32 m0, s55, 65280
    s_add_u32 s56, s54, 30720
    buffer_load_dwordx4 v6, s[24:27], s56 offen nt lds
    s_add_u32 m0, s55, 66240
    s_add_u32 s56, s54, 38400
    buffer_load_dwordx4 v6, s[24:27], s56 offen nt lds
    s_add_u32 m0, s55, 67200
    s_add_u32 s56, s54, 46080
    buffer_load_dwordx4 v6, s[24:27], s56 offen nt lds
    s_add_u32 m0, s55, 68160
    s_add_u32 s56, s54, 53760
    buffer_load_dwordx4 v6, s[24:27], s56 offen nt lds
    s_mov_b64 exec, -1
    s_waitcnt vmcnt(29)
    s_waitcnt vmcnt(14)
    s_branch Lr_158
Lx_148:
    s_cmp_eq_u32 s10, 0
    s_cbranch_scc1 Lx_157
Lr_158:
    s_branch Lr_149
Lx_160:
    s_mov_b64 exec, 0x101
    buffer_store_dword v3, v1, s[20:23], s33 offen sc1
    s_mov_b64 exec, s[36:37]
    v_add_f32_dpp v2, v12, v13 quad_perm:[0,1,2,3] row_mask:0x1 bank_mask:0xf
    v_add_f32_dpp v2, v16, v17 quad_perm:[0,1,2,3] row_mask:0x2 bank_mask:0xf
    v_add_f32_dpp v2, v20, v21 quad_perm:[0,1,2,3] row_mask:0x4 bank_mask:0xf
    buffer_store_dword v2, v5, s[20:23], s32 offen sc1
    s_mov_b64 exec, -1
    s_branch Lr_161
Lx_164:
    s_mov_b64 exec, s[36:37]
    buffer_store_dword v2, v5, s[20:23], s29 offen sc1
    s_mov_b64 exec, -1
    s_branch Lr_165
Lx_162:
    s_add_u32 s29, s32, 24576
    v_add_f32_dpp v2, v14, v15 quad_perm:[0,1,2,3] row_mask:0x1 bank_mask:0xf
    v_add_f32_dpp v2, v18, v19 quad_perm:[0,1,2,3] row_mask:0x2 bank_mask:0xf
    v_add_f32_dpp v2, v22, v23 quad_perm:[0,1,2,3] row_mask:0x4 bank_mask:0xf
    s_cmp_eq_u32 s3, 0
    s_cbranch_scc1 Lx_164
    s_mov_b64 exec, s[36:37]
    buffer_store_dword v2, v5, s[20:23], s29 offen
    s_mov_b64 exec, -1
Lr_165:
    s_branch Lr_163
Lx_171:
    s_lshl_b32 s54, s9, 1
    s_min_u32 s54, s54, 5
    s_mul_i32 s54, s54, 6144
    s_add_u32 s54, s54, 92160
    v_and_b32 v32, 7, v0
    v_and_b32 v33, 6, v0
    v_lshrrev_b32 v34, 4, v0
    v_xor_b32 v33, v33, v34
    v_lshlrev_b32 v32, 7, v32
    v_lshl_add_u32 v32, v33, 4, v32
    v_bfe_u32 v33, v0, 3, 1
    v_mul_u32_u24 v33, 3072, v33
    v_add3_u32 v32, v32, v33, s54
    v_xor_b32 v33, 64, v32
    ds_read_b128 a[192:195], v32 offset:0
    ds_read_b128 a[196:199], v33 offset:0
    ds_read_b128 a[200:203], v32 offset:1024
    ds_read_b128 a[204:207], v33 offset:1024
    ds_read_b128 a[208:211], v32 offset:2048
    ds_read_b128 a[212:215], v33 offset:2048
    s_cmp_ge_u32 s9, 2
    s_cbranch_scc1 Ls_173
    ds_read_b128 a[216:219], v32 offset:6144
    ds_read_b128 a[220:223], v33 offset:6144
    ds_read_b128 a[224:227], v32 offset:7168
    ds_read_b128 a[228:231], v33 offset:7168
    ds_read_b128 a[232:235], v32 offset:8192
    ds_read_b128 a[236:239], v33 offset:8192
Ls_173:
    s_branch Lr_172
Lx_174:
    s_add_u32 s29, s28, 24576
    buffer_load_dword v20, v54, s[20:23], s29 offen offset:0 sc1
    buffer_load_dword v21, v54, s[20:23], s29 offen offset:256 sc1
    buffer_load_dword v22, v54, s[20:23], s29 offen offset:512 sc1
    buffer_load_dword v23, v54, s[20:23], s29 offen offset:768 sc1
    buffer_load_dword v24, v54, s[20:23], s29 offen offset:1024 sc1
    buffer_load_dword v25, v54, s[20:23], s29 offen offset:1280 sc1
    buffer_load_dword v26, v54, s[20:23], s29 offen offset:1536 sc1
    buffer_load_dword v27, v54, s[20:23], s29 offen offset:1792 sc1
    s_waitcnt vmcnt(0)
    v_pk_add_f32 v[20:21], v[20:21], v[22:23]
    v_pk_add_f32 v[24:25], v[24:25], v[26:27]
    v_pk_add_f32 v[20:21], v[20:21], v[24:25]
    v_add_f32 v20, v20, v21
    v_mul_f32 v62, 986500301, v20
    s_branch Lc_168
Lc_168:
    v_add_f32 v12, v12, v13
    v_add_f32 v12, v12, v14
    v_add_f32 v16, v16, v17
    v_add_f32 v16, v16, v18
    v_add_f32_dpp v12, v12, v12 quad_perm:[1,0,3,2] row_mask:0xf bank_mask:0xf
    s_nop 1
    v_add_f32_dpp v12, v12, v12 quad_perm:[2,3,0,1] row_mask:0xf bank_mask:0xf
    s_nop 1
    v_add_f32_dpp v12, v12, v12 row_half_mirror row_mask:0xf bank_mask:0xf
    s_branch Lc2_175
Lcold_170:
    s_cmp_ge_u32 s53, 40
    s_cbranch_scc1 Lex_176
    s_waitcnt lgkmcnt(0)
    s_cmp_lg_u32 s10, 0
    s_cbranch_scc1 Ls_177
    s_mov_b32 s48, 0
Lpoll_178:
    buffer_load_dword v20, v54, s[20:23], s29 offen offset:0 sc1
    buffer_load_dword v21, v54, s[20:23], s29 offen offset:256 sc1
    buffer_load_dword v22, v54, s[20:23], s29 offen offset:512 sc1
    buffer_load_dword v23, v54, s[20:23], s29 offen offset:768 sc1
    buffer_load_dword v24, v54, s[20:23], s29 offen offset:1024 sc1
    buffer_load_dword v25, v54, s[20:23], s29 offen offset:1280 sc1
    buffer_load_dword v26, v54, s[20:23], s29 offen offset:1536 sc1
    buffer_load_dword v27, v54, s[20:23], s29 offen offset:1792 sc1
    s_waitcnt vmcnt(0)
    v_max3_u32 v15, v20, v21, v22
    v_max3_u32 v15, v15, v23, v24
    v_max3_u32 v15, v15, v25, v26
    v_max_u32 v15, v15, v27
    v_cmp_eq_u32 vcc, -1, v15
    s_cbranch_vccz Lgot_179
    s_add_u32 s48, s48, 1
    s_cmp_lt_u32 s48, s47
    s_cbranch_scc1 Lpoll_178
    s_mov_b32 s47, 0
Lgot_179:
    v_pk_add_f32 v[20:21], v[20:21], v[22:23]
    v_pk_add_f32 v[24:25], v[24:25], v[26:27]
    v_pk_add_f32 v[20:21], v[20:21], v[24:25]
    v_add_f32 v20, v20, v21
    v_mul_f32 v62, 986500301, v20
Ls_177:
    buffer_load_dwordx3 v[12:14], v55, s[20:23], s28 offen sc1
    buffer_load_dwordx3 v[16:18], v55, s[20:23], s28 offen offset:16 sc1
    buffer_load_dword v4, v54, s[20:23], s28 offen offset:0 sc1
    buffer_load_dword v5, v54, s[20:23], s28 offen offset:256 sc1
    buffer_load_dword v6, v54, s[20:23], s28 offen offset:512 sc1
    buffer_load_dword v7, v54, s[20:23], s28 offen offset:768 sc1
    buffer_load_dword v8, v54, s[20:23], s28 offen offset:1024 sc1
    buffer_load_dword v9, v54, s[20:23], s28 offen offset:1280 sc1
    buffer_load_dword v10, v54, s[20:23], s28 offen offset:1536 sc1
    buffer_load_dword v11, v54, s[20:23], s28 offen offset:1792 sc1
    s_add_u32 s53, s53, 1
    s_waitcnt vmcnt(0)
    s_branch Lc_168
Lex_176:
    s_cmp_gt_u32 s53, 40
    s_cbranch_scc1 Lok_169
    s_waitcnt lgkmcnt(0)
    s_cmp_lg_u32 s10, 0
    s_cbranch_scc1 Ls_180
    s_mov_b32 s48, 0
Lpoll_181:
    buffer_load_dword v20, v54, s[20:23], s29 offen offset:0 sc1
    buffer_load_dword v21, v54, s[20:23], s29 offen offset:256 sc1
    buffer_load_dword v22, v54, s[20:23], s29 offen offset:512 sc1
    buffer_load_dword v23, v54, s[20:23], s29 offen offset:768 sc1
    buffer_load_dword v24, v54, s[20:23], s29 offen offset:1024 sc1
    buffer_load_dword v25, v54, s[20:23], s29 offen offset:1280 sc1
    buffer_load_dword v26, v54, s[20:23], s29 offen offset:1536 sc1
    buffer_load_dword v27, v54, s[20:23], s29 offen offset:1792 sc1
    s_waitcnt vmcnt(0)
    v_max3_u32 v15, v20, v21, v22
    v_max3_u32 v15, v15, v23, v24
    v_max3_u32 v15, v15, v25, v26
    v_max_u32 v15, v15, v27
    v_cmp_eq_u32 vcc, -1, v15
    s_cbranch_vccz Lgot_182
    s_add_u32 s48, s48, 1
    s_cmp_lt_u32 s48, s47
    s_cbranch_scc1 Lpoll_181
    s_mov_b32 s47, 0
Lgot_182:
    v_pk_add_f32 v[20:21], v[20:21], v[22:23]
    v_pk_add_f32 v[24:25], v[24:25], v[26:27]
    v_pk_add_f32 v[20:21], v[20:21], v[24:25]
    v_add_f32 v20, v20, v21
    v_mul_f32 v62, 986500301, v20
Ls_180:
    s_mov_b32 s48, 0
Lpoll_183:
    buffer_load_dwordx3 v[12:14], v55, s[20:23], s28 offen sc1
    buffer_load_dwordx3 v[16:18], v55, s[20:23], s28 offen offset:16 sc1
    buffer_load_dword v4, v54, s[20:23], s28 offen offset:0 sc1
    buffer_load_dword v5, v54, s[20:23], s28 offen offset:256 sc1
    buffer_load_dword v6, v54, s[20:23], s28 offen offset:512 sc1
    buffer_load_dword v7, v54, s[20:23], s28 offen offset:768 sc1
    buffer_load_dword v8, v54, s[20:23], s28 offen offset:1024 sc1
    buffer_load_dword v9, v54, s[20:23], s28 offen offset:1280 sc1
    buffer_load_dword v10, v54, s[20:23], s28 offen offset:1536 sc1
    buffer_load_dword v11, v54, s[20:23], s28 offen offset:1792 sc1
    s_waitcnt vmcnt(0)
    v_max3_u32 v15, v4, v5, v6
    v_max3_u32 v15, v15, v7, v8
    v_max3_u32 v15, v15, v9, v10
    v_max3_u32 v15, v15, v11, v12
    v_max3_u32 v15, v15, v13, v14
    v_max3_u32 v15, v15, v16, v17
    v_max_u32 v15, v15, v18
    v_cmp_eq_u32 vcc, -1, v15
    s_cbranch_vccz Lgot_184
    s_add_u32 s48, s48, 1
    s_cmp_lt_u32 s48, s47
    s_cbranch_scc1 Lpoll_183
    s_mov_b32 s47, 0
Lgot_184:
    s_add_u32 s53, s53, 1
    s_branch Lc_168
Lx_185:
    s_lshl_b32 s54, s9, 1
    s_min_u32 s54, s54, 5
    s_mul_i32 s54, s54, 6144
    s_add_u32 s54, s54, 92160
    v_and_b32 v32, 7, v0
    v_and_b32 v33, 6, v0
    v_lshrrev_b32 v34, 4, v0
    v_xor_b32 v33, v33, v34
    v_lshlrev_b32 v32, 7, v32
    v_lshl_add_u32 v32, v33, 4, v32
    v_bfe_u32 v33, v0, 3, 1
    v_mul_u32_u24 v33, 3072, v33
    v_add3_u32 v32, v32, v33, s54
    v_xor_b32 v33, 64, v32
    ds_read_b128 a[192:195], v32 offset:0
    ds_read_b128 a[196:199], v33 offset:0
    ds_read_b128 a[200:203], v32 offset:1024
    ds_read_b128 a[204:207], v33 offset:1024
    ds_read_b128 a[208:211], v32 offset:2048
    ds_read_b128 a[212:215], v33 offset:2048
    s_cmp_ge_u32 s9, 2
    s_cbranch_scc1 Ls_187
    ds_read_b128 a[216:219], v32 offset:6144
    ds_read_b128 a[220:223], v33 offset:6144
    ds_read_b128 a[224:227], v32 offset:7168
    ds_read_b128 a[228:231], v33 offset:7168
    ds_read_b128 a[232:235], v32 offset:8192
    ds_read_b128 a[236:239], v33 offset:8192
Ls_187:
    s_branch Lr_186
Lx_166:
    v_and_b32 v53, 1, v0
    v_lshlrev_b32 v53, 4, v53
    v_lshrrev_b32 v52, 4, v0
    v_lshl_add_u32 v52, v52, 5, v53
    v_add_u32 v52, 162304, v52
    v_and_b32 v53, 1, v0
    v_mul_u32_u24 v53, 0xaaaa, v53
    v_or_b32 v53, 0x4444, v53
    v_lshlrev_b32 v50, 1, v0
    v_mov_b64 v[40:41], 0
    v_mov_b64 v[44:45], 0
    s_cmp_eq_u32 s10, 0
    s_cbranch_scc1 Lx_185
Lr_186:
    s_waitcnt vmcnt(0)
    s_branch Lr_167
Lx_188:
    s_mov_b32 s24, s82
    s_mov_b32 s25, s83
    s_mov_b32 s26, 9437184
    s_mov_b32 s27, 0x00020000
    s_mul_i32 s54, s6, 1179648
    s_mul_i32 s55, s5, 384
    s_add_u32 s54, s54, s55
    v_lshrrev_b32 v6, 3, v0
    v_and_b32 v7, 6, v6
    v_xor_b32 v7, v7, v0
    v_and_b32 v7, 7, v7
    v_mul_u32_u24 v6, 12288, v6
    v_lshl_add_u32 v6, v7, 4, v6
    s_mul_i32 s55, s9, 294912
    s_add_u32 s54, s54, s55
    s_mul_i32 s55, s9, 9216
    s_add_u32 m0, s55, 92160
    s_add_u32 s56, s54, 0
    buffer_load_dwordx4 v6, s[24:27], s56 offen nt lds
    s_add_u32 m0, s55, 93184
    s_add_u32 s56, s54, 128
    buffer_load_dwordx4 v6, s[24:27], s56 offen nt lds
    s_add_u32 m0, s55, 94208
    s_add_u32 s56, s54, 256
    buffer_load_dwordx4 v6, s[24:27], s56 offen nt lds
    s_add_u32 m0, s55, 95232
    s_add_u32 s56, s54, 98304
    buffer_load_dwordx4 v6, s[24:27], s56 offen nt lds
    s_add_u32 m0, s55, 96256
    s_add_u32 s56, s54, 98432
    buffer_load_dwordx4 v6, s[24:27], s56 offen nt lds
    s_add_u32 m0, s55, 97280
    s_add_u32 s56, s54, 98560
    buffer_load_dwordx4 v6, s[24:27], s56 offen nt lds
    s_add_u32 m0, s55, 98304
    s_add_u32 s56, s54, 196608
    buffer_load_dwordx4 v6, s[24:27], s56 offen nt lds
    s_add_u32 m0, s55, 99328
    s_add_u32 s56, s54, 196736
    buffer_load_dwordx4 v6, s[24:27], s56 offen nt lds
    s_add_u32 m0, s55, 100352
    s_add_u32 s56, s54, 196864
    buffer_load_dwordx4 v6, s[24:27], s56 offen nt lds
    s_branch Lr_189
Lcold_192:
    s_cmp_ge_u32 s53, 40
    s_cbranch_scc1 Lex_193
    s_waitcnt lgkmcnt(0)
    s_mov_b64 exec, vcc
    buffer_load_dwordx4 v[4:7], v2, s[20:23], s94 offen offset:0 sc1
    buffer_load_dwordx4 v[8:11], v2, s[20:23], s94 offen offset:1024 sc1
    buffer_load_dwordx4 v[12:15], v2, s[20:23], s94 offen offset:2048 sc1
    buffer_load_dwordx4 v[16:19], v2, s[20:23], s94 offen offset:3072 sc1
    buffer_load_dwordx4 v[20:23], v2, s[20:23], s28 offen offset:0 sc1
    buffer_load_dwordx4 v[24:27], v2, s[20:23], s28 offen offset:1024 sc1
    s_mov_b64 exec, -1
    s_add_u32 s53, s53, 1
    ds_read_b128 v[28:31], v1 offset:0
    ds_read_b128 v[32:35], v3 offset:0
    ds_read_b128 v[36:39], v1 offset:1024
    ds_read_b128 v[40:43], v3 offset:1024
    ds_read_b128 v[44:47], v1 offset:2048
    v_lshlrev_b32 v60, 4, v0
    s_waitcnt vmcnt(0)
    s_branch Lc_190
Lex_193:
    s_cmp_gt_u32 s53, 40
    s_cbranch_scc1 Lok_191
    s_waitcnt lgkmcnt(0)
    s_mov_b32 s48, 0
Lpoll_194:
    buffer_load_dwordx4 v[4:7], v2, s[20:23], s94 offen offset:0 sc1
    buffer_load_dwordx4 v[8:11], v2, s[20:23], s94 offen offset:1024 sc1
    buffer_load_dwordx4 v[12:15], v2, s[20:23], s94 offen offset:2048 sc1
    buffer_load_dwordx4 v[16:19], v2, s[20:23], s94 offen offset:3072 sc1
    buffer_load_dwordx4 v[20:23], v2, s[20:23], s28 offen offset:0 sc1
    buffer_load_dwordx4 v[24:27], v2, s[20:23], s28 offen offset:1024 sc1
    s_waitcnt vmcnt(0)
    v_max3_u32 v60, v4, v5, v6
    v_max3_u32 v60, v60, v7, v8
    v_max3_u32 v60, v60, v9, v10
    v_max3_u32 v60, v60, v11, v12
    v_max3_u32 v60, v60, v13, v14
    v_max3_u32 v60, v60, v15, v16
    v_max3_u32 v60, v60, v17, v18
    v_max3_u32 v60, v60, v19, v20
    v_max3_u32 v60, v60, v21, v22
    v_max3_u32 v60, v60, v23, v24
    v_max3_u32 v60, v60, v25, v26
    v_max_u32 v60, v60, v27
    v_cmp_eq_u32 vcc, -1, v60
    s_cbranch_vccz Lgot_195
    s_add_u32 s48, s48, 1
    s_cmp_lt_u32 s48, s47
    s_cbranch_scc1 Lpoll_194
    s_mov_b32 s47, 0
Lgot_195:
    ds_read_b128 v[28:31], v1 offset:0
    ds_read_b128 v[32:35], v3 offset:0
    ds_read_b128 v[36:39], v1 offset:1024
    ds_read_b128 v[40:43], v3 offset:1024
    ds_read_b128 v[44:47], v1 offset:2048
    v_lshlrev_b32 v60, 4, v0
    s_add_u32 s53, s53, 1
    s_branch Lc_190
Lx_196:
    buffer_store_dwordx4 v[52:55], v60, s[20:23], s95 offen sc1
    buffer_store_dwordx4 v[48:51], v60, s[20:23], s95 offen offset:1024 sc1
    s_branch Lr_197
Lcold_200:
    s_cmp_ge_u32 s53, 40
    s_cbranch_scc1 Lex_201
    s_waitcnt lgkmcnt(0)
    buffer_load_dwordx4 v[4:7], v60, s[20:23], s29 offen sc1
    buffer_load_dwordx4 v[8:11], v60, s[20:23], s29 offen offset:1024 sc1
    buffer_load_dwordx4 v[12:15], v60, s[20:23], s30 offen sc1
    buffer_load_dwordx4 v[16:19], v60, s[20:23], s30 offen offset:1024 sc1
    buffer_load_dwordx4 v[20:23], v60, s[20:23], s31 offen sc1
    buffer_load_dwordx4 v[24:27], v60, s[20:23], s31 offen offset:1024 sc1
    s_add_u32 s53, s53, 1
    s_waitcnt vmcnt(0)
    s_branch Lc_198
Lex_201:
    s_cmp_gt_u32 s53, 40
    s_cbranch_scc1 Lok_199
    s_waitcnt lgkmcnt(0)
    s_mov_b32 s48, 0
Lpoll_202:
    buffer_load_dwordx4 v[4:7], v60, s[20:23], s29 offen sc1
    buffer_load_dwordx4 v[8:11], v60, s[20:23], s29 offen offset:1024 sc1
    buffer_load_dwordx4 v[12:15], v60, s[20:23], s30 offen sc1
    buffer_load_dwordx4 v[16:19], v60, s[20:23], s30 offen offset:1024 sc1
    buffer_load_dwordx4 v[20:23], v60, s[20:23], s31 offen sc1
    buffer_load_dwordx4 v[24:27], v60, s[20:23], s31 offen offset:1024 sc1
    s_waitcnt vmcnt(0)
    v_max3_u32 v3, v4, v5, v6
    v_max3_u32 v3, v3, v7, v8
    v_max3_u32 v3, v3, v9, v10
    v_max3_u32 v3, v3, v11, v12
    v_max3_u32 v3, v3, v13, v14
    v_max3_u32 v3, v3, v15, v16
    v_max3_u32 v3, v3, v17, v18
    v_max3_u32 v3, v3, v19, v20
    v_max3_u32 v3, v3, v21, v22
    v_max3_u32 v3, v3, v23, v24
    v_max3_u32 v3, v3, v25, v26
    v_max_u32 v3, v3, v27
    v_cmp_eq_u32 vcc, -1, v3
    s_cbranch_vccz Lgot_203
    s_add_u32 s48, s48, 1
    s_cmp_lt_u32 s48, s47
    s_cbranch_scc1 Lpoll_202
    s_mov_b32 s47, 0
Lgot_203:
    s_add_u32 s53, s53, 1
    s_branch Lc_198
Lcold_208:
    s_cmp_ge_u32 s53, 40
    s_cbranch_scc1 Lex_209
    s_waitcnt lgkmcnt(0)
    v_lshrrev_b32 v2, 2, v0
    v_mul_u32_u24 v1, 384, v2
    v_lshlrev_b32 v2, 10, v2
    v_and_b32 v3, 3, v0
    v_lshl_add_u32 v1, v3, 4, v1
    buffer_load_dwordx2 v[20:21], v2, s[20:23], s101 offen sc1
    buffer_load_dwordx2 v[22:23], v2, s[20:23], s31 offen sc1
    buffer_load_dwordx2 v[24:25], v2, s[20:23], s32 offen sc1
    buffer_load_dwordx2 v[26:27], v2, s[20:23], s33 offen sc1
    buffer_load_dwordx4 v[4:7], v1, s[20:23], s99 offen sc1
    buffer_load_dwordx4 v[8:11], v1, s[20:23], s28 offen sc1
    buffer_load_dwordx4 v[12:15], v1, s[20:23], s29 offen sc1
    buffer_load_dwordx4 v[16:19], v1, s[20:23], s30 offen sc1
    s_add_u32 s53, s53, 1
    v_and_b32 v2, 32, v0
    v_lshrrev_b32 v2, 2, v2
    v_and_b32 v3, 16, v0
    v_lshl_or_b32 v2, v3, 0, v2
    v_and_b32 v3, 2, v0
    v_lshl_or_b32 v2, v3, 1, v2
    v_and_b32 v3, 1, v0
    v_lshl_or_b32 v2, v3, 5, v2
    v_and_b32 v1, 16, v0
    v_lshrrev_b32 v1, 2, v1
    v_and_b32 v3, 32, v0
    v_lshrrev_b32 v3, 1, v3
    v_or_b32 v1, v3, v1
    v_and_b32 v3, 2, v0
    v_lshl_or_b32 v1, v3, 2, v1
    v_and_b32 v3, 1, v0
    v_lshl_or_b32 v1, v3, 5, v1
    s_cmp_eq_u32 s9, 2
    s_cselect_b64 vcc, -1, 0
    s_lshl_b32 s54, s9, 6
    s_add_u32 s54, s54, 162688
    v_cndmask_b32 v2, v2, v1, vcc
    v_add_u32 v2, s54, v2
    v_mov_b64 v[52:53], 0
    v_mov_b64 v[54:55], 0
    s_waitcnt vmcnt(4)
    v_max3_f32 v3, v20, v22, v24
    v_max_f32 v3, v3, v26
    s_nop 1
    v_max_f32_dpp v3, v3, v3 row_ror:4 row_mask:0xf bank_mask:0xf
    s_nop 1
    v_max_f32_dpp v3, v3, v3 row_ror:8 row_mask:0xf bank_mask:0xf
    v_mov_b32 v1, v3
    s_nop 1
    v_permlane16_swap_b32 v3, v1
    v_max_f32 v3, v3, v1
    v_mov_b32 v1, v3
    s_nop 1
    v_permlane32_swap_b32 v3, v1
    v_max_f32 v3, v3, v1
    v_sub_f32 v20, v20, v3
    v_sub_f32 v22, v22, v3
    v_sub_f32 v24, v24, v3
    v_sub_f32 v26, v26, v3
    v_exp_f32 v20, v20
    v_exp_f32 v22, v22
    v_exp_f32 v24, v24
    v_exp_f32 v26, v26
    v_and_b32 v20, 0xffff0000, v20
    v_and_b32 v22, 0xffff0000, v22
    v_and_b32 v24, 0xffff0000, v24
    v_and_b32 v26, 0xffff0000, v26
    v_mul_f32 v3, v20, v21
    v_fmac_f32 v3, v22, v23
    v_fmac_f32 v3, v24, v25
    v_fmac_f32 v3, v26, v27
    v_lshrrev_b32 v21, 16, v20
    v_lshrrev_b32 v23, 16, v22
    v_add_f32_dpp v3, v3, v3 row_ror:4 row_mask:0xf bank_mask:0xf
    v_lshrrev_b32 v25, 16, v24
    v_lshrrev_b32 v27, 16, v26
    v_add_f32_dpp v3, v3, v3 row_ror:8 row_mask:0xf bank_mask:0xf
    v_mov_b32 v1, v3
    s_nop 1
    v_permlane16_swap_b32 v3, v1
    v_add_f32 v3, v3, v1
    v_mov_b32 v1, v3
    s_nop 1
    v_permlane32_swap_b32 v3, v1
    v_add_f32 v3, v3, v1
    v_rcp_f32 v3, v3
    s_nop 0
    v_mul_f32 v3, s0, v3
    s_waitcnt vmcnt(0)
    s_branch Lc_206
Lex_209:
    s_cmp_gt_u32 s53, 40
    s_cbranch_scc1 Lok_207
    s_waitcnt lgkmcnt(0)
    v_lshrrev_b32 v2, 2, v0
    v_mul_u32_u24 v1, 384, v2
    v_lshlrev_b32 v2, 10, v2
    v_and_b32 v3, 3, v0
    v_lshl_add_u32 v1, v3, 4, v1
    s_mov_b32 s48, 0
Lpoll_210:
    buffer_load_dwordx2 v[20:21], v2, s[20:23], s101 offen sc1
    buffer_load_dwordx2 v[22:23], v2, s[20:23], s31 offen sc1
    buffer_load_dwordx2 v[24:25], v2, s[20:23], s32 offen sc1
    buffer_load_dwordx2 v[26:27], v2, s[20:23], s33 offen sc1
    buffer_load_dwordx4 v[4:7], v1, s[20:23], s99 offen sc1
    buffer_load_dwordx4 v[8:11], v1, s[20:23], s28 offen sc1
    buffer_load_dwordx4 v[12:15], v1, s[20:23], s29 offen sc1
    buffer_load_dwordx4 v[16:19], v1, s[20:23], s30 offen sc1
    s_waitcnt vmcnt(0)
    v_max3_u32 v3, v4, v5, v6
    v_max3_u32 v3, v3, v7, v8
    v_max3_u32 v3, v3, v9, v10
    v_max3_u32 v3, v3, v11, v12
    v_max3_u32 v3, v3, v13, v14
    v_max3_u32 v3, v3, v15, v16
    v_max3_u32 v3, v3, v17, v18
    v_max3_u32 v3, v3, v19, v20
    v_max3_u32 v3, v3, v21, v22
    v_max3_u32 v3, v3, v23, v24
    v_max3_u32 v3, v3, v25, v26
    v_max_u32 v3, v3, v27
    v_cmp_eq_u32 vcc, -1, v3
    s_cbranch_vccz Lgot_211
    s_add_u32 s48, s48, 1
    s_cmp_lt_u32 s48, s47
    s_cbranch_scc1 Lpoll_210
    s_mov_b32 s47, 0
Lgot_211:
    v_and_b32 v2, 32, v0
    v_lshrrev_b32 v2, 2, v2
    v_and_b32 v3, 16, v0
    v_lshl_or_b32 v2, v3, 0, v2
    v_and_b32 v3, 2, v0
    v_lshl_or_b32 v2, v3, 1, v2
    v_and_b32 v3, 1, v0
    v_lshl_or_b32 v2, v3, 5, v2
    v_and_b32 v1, 16, v0
    v_lshrrev_b32 v1, 2, v1
    v_and_b32 v3, 32, v0
    v_lshrrev_b32 v3, 1, v3
    v_or_b32 v1, v3, v1
    v_and_b32 v3, 2, v0
    v_lshl_or_b32 v1, v3, 2, v1
    v_and_b32 v3, 1, v0
    v_lshl_or_b32 v1, v3, 5, v1
    s_cmp_eq_u32 s9, 2
    s_cselect_b64 vcc, -1, 0
    s_lshl_b32 s54, s9, 6
    s_add_u32 s54, s54, 162688
    v_cndmask_b32 v2, v2, v1, vcc
    v_add_u32 v2, s54, v2
    v_mov_b64 v[52:53], 0
    v_mov_b64 v[54:55], 0
    s_waitcnt vmcnt(4)
    v_max3_f32 v3, v20, v22, v24
    v_max_f32 v3, v3, v26
    s_nop 1
    v_max_f32_dpp v3, v3, v3 row_ror:4 row_mask:0xf bank_mask:0xf
    s_nop 1
    v_max_f32_dpp v3, v3, v3 row_ror:8 row_mask:0xf bank_mask:0xf
    v_mov_b32 v1, v3
    s_nop 1
    v_permlane16_swap_b32 v3, v1
    v_max_f32 v3, v3, v1
    v_mov_b32 v1, v3
    s_nop 1
    v_permlane32_swap_b32 v3, v1
    v_max_f32 v3, v3, v1
    v_sub_f32 v20, v20, v3
    v_sub_f32 v22, v22, v3
    v_sub_f32 v24, v24, v3
    v_sub_f32 v26, v26, v3
    v_exp_f32 v20, v20
    v_exp_f32 v22, v22
    v_exp_f32 v24, v24
    v_exp_f32 v26, v26
    v_and_b32 v20, 0xffff0000, v20
    v_and_b32 v22, 0xffff0000, v22
    v_and_b32 v24, 0xffff0000, v24
    v_and_b32 v26, 0xffff0000, v26
    v_mul_f32 v3, v20, v21
    v_fmac_f32 v3, v22, v23
    v_fmac_f32 v3, v24, v25
    v_fmac_f32 v3, v26, v27
    v_lshrrev_b32 v21, 16, v20
    v_lshrrev_b32 v23, 16, v22
    v_add_f32_dpp v3, v3, v3 row_ror:4 row_mask:0xf bank_mask:0xf
    v_lshrrev_b32 v25, 16, v24
    v_lshrrev_b32 v27, 16, v26
    v_add_f32_dpp v3, v3, v3 row_ror:8 row_mask:0xf bank_mask:0xf
    v_mov_b32 v1, v3
    s_nop 1
    v_permlane16_swap_b32 v3, v1
    v_add_f32 v3, v3, v1
    v_mov_b32 v1, v3
    s_nop 1
    v_permlane32_swap_b32 v3, v1
    v_add_f32 v3, v3, v1
    v_rcp_f32 v3, v3
    s_nop 0
    v_mul_f32 v3, s0, v3
    s_add_u32 s53, s53, 1
    s_branch Lc_206
Lx_204:
    s_cmp_lg_u32 s10, 0
    s_cbranch_scc1 Ls_212
    s_cmp_eq_u32 s3, 0
    s_cbranch_scc1 Ls_213
    v_lshrrev_b32 v22, 4, v0
    v_mul_u32_u24 v22, 1792, v22
    v_lshl_add_u32 v21, v0, 4, v22
    s_lshl_b32 s55, s6, 8
    s_mul_i32 s56, s6, 224
    v_add_u32 v21, s55, v21
    v_subrev_u32 v22, s56, v21
    v_cmp_gt_u32 vcc, 48, v0
    s_sub_u32 s54, s52, 6144
    s_nop 0
    v_cndmask_b32 v21, v22, v21, vcc
    s_mov_b32 exec_hi, 0x3ffff
    s_add_u32 s28, s54, 24576
    buffer_load_dword v63, v21, s[20:23], s28 offen sc1
    s_add_u32 s28, s54, 2097152
    buffer_load_dword v63, v21, s[20:23], s28 offen sc1
    s_add_u32 s28, s54, 2105344
    buffer_load_dword v63, v21, s[20:23], s28 offen sc1
    s_mov_b64 exec, -1
Ls_213:
    s_waitcnt vmcnt(0)
Ls_212:
    s_waitcnt lgkmcnt(0)
    ds_read_b64_tr_b16 v[8:9], v60 offset:0
    ds_read_b64_tr_b16 v[10:11], v60 offset:6144
    ds_read_b64_tr_b16 v[12:13], v60 offset:12288
    ds_read_b64_tr_b16 v[14:15], v60 offset:18432
    ds_read_b64_tr_b16 v[16:17], v60 offset:24576
    ds_read_b64_tr_b16 v[18:19], v60 offset:30720
    s_branch Lr_205
Lx_214:
    s_mov_b64 exec, s[36:37]
    v_add_f32_dpp v2, v52, v53 quad_perm:[0,1,2,3] row_mask:0x1 bank_mask:0xf
    v_add_f32_dpp v2, v4, v5 quad_perm:[0,1,2,3] row_mask:0x2 bank_mask:0xf
    v_add_f32_dpp v2, v36, v37 quad_perm:[0,1,2,3] row_mask:0x4 bank_mask:0xf
    buffer_store_dword v2, v60, s[20:23], s32 offen sc1
    s_mov_b64 exec, -1
    s_branch Lr_215
Lcold_220:
    s_cmp_ge_u32 s53, 40
    s_cbranch_scc1 Lex_221
    s_waitcnt lgkmcnt(0)
    buffer_load_dword v4, v26, s[20:23], s28 offen offset:0 sc1
    buffer_load_dword v5, v26, s[20:23], s28 offen offset:256 sc1
    buffer_load_dword v6, v26, s[20:23], s28 offen offset:512 sc1
    buffer_load_dword v7, v26, s[20:23], s28 offen offset:768 sc1
    buffer_load_dword v8, v26, s[20:23], s28 offen offset:1024 sc1
    buffer_load_dword v9, v26, s[20:23], s28 offen offset:1280 sc1
    buffer_load_dword v10, v26, s[20:23], s28 offen offset:1536 sc1
    buffer_load_dword v11, v26, s[20:23], s28 offen offset:1792 sc1
    s_add_u32 s53, s53, 1
    s_waitcnt vmcnt(0)
    s_branch Lc_218
Lex_221:
    s_cmp_gt_u32 s53, 40
    s_cbranch_scc1 Lok_219
    s_waitcnt lgkmcnt(0)
    s_mov_b32 s48, 0
Lpoll_222:
    buffer_load_dword v4, v26, s[20:23], s28 offen offset:0 sc1
    buffer_load_dword v5, v26, s[20:23], s28 offen offset:256 sc1
    buffer_load_dword v6, v26, s[20:23], s28 offen offset:512 sc1
    buffer_load_dword v7, v26, s[20:23], s28 offen offset:768 sc1
    buffer_load_dword v8, v26, s[20:23], s28 offen offset:1024 sc1
    buffer_load_dword v9, v26, s[20:23], s28 offen offset:1280 sc1
    buffer_load_dword v10, v26, s[20:23], s28 offen offset:1536 sc1
    buffer_load_dword v11, v26, s[20:23], s28 offen offset:1792 sc1
    s_waitcnt vmcnt(0)
    v_max3_u32 v15, v4, v5, v6
    v_max3_u32 v15, v15, v7, v8
    v_max3_u32 v15, v15, v9, v10
    v_max_u32 v15, v15, v11
    v_cmp_eq_u32 vcc, -1, v15
    s_cbranch_vccz Lgot_223
    s_add_u32 s48, s48, 1
    s_cmp_lt_u32 s48, s47
    s_cbranch_scc1 Lpoll_222
    s_mov_b32 s47, 0
Lgot_223:
    s_add_u32 s53, s53, 1
    s_branch Lc_218
Lx_216:
    v_lshrrev_b32 v28, 2, v0
    v_mul_u32_u24 v28, 160, v28
    v_and_b32 v29, 3, v0
    v_lshl_add_u32 v28, v29, 3, v28
    s_lshl_b32 s54, s9, 5
    s_add_u32 s54, s54, 61440
    v_add_u32 v28, s54, v28
    ds_read_b64_tr_b16 v[30:31], v28 offset:0
    ds_read_b64_tr_b16 v[32:33], v28 offset:2560
    ds_read_b64_tr_b16 v[34:35], v28 offset:5120
    ds_read_b64_tr_b16 v[36:37], v28 offset:7680
    ds_read_b64_tr_b16 v[38:39], v28 offset:10240
    ds_read_b64_tr_b16 v[40:41], v28 offset:12800
    ds_read_b64_tr_b16 v[42:43], v28 offset:15360
    ds_read_b64_tr_b16 v[44:45], v28 offset:17920
    ds_read_b64_tr_b16 v[46:47], v28 offset:20480
    ds_read_b64_tr_b16 v[48:49], v28 offset:23040
    ds_read_b64_tr_b16 v[50:51], v28 offset:25600
    ds_read_b64_tr_b16 v[52:53], v28 offset:28160
    v_and_b32 v29, 1, v0
    v_lshlrev_b32 v29, 4, v29
    v_lshrrev_b32 v55, 4, v0
    v_lshl_add_u32 v55, v55, 5, v29
    v_add_u32 v55, 162304, v55
    v_and_b32 v29, 1, v0
    v_mul_u32_u24 v29, 0xaaaa, v29
    v_or_b32 v29, 0x4444, v29
    v_mov_b64 v[22:23], 0
    v_mov_b32 v1, v29
    v_mov_b32 v54, v28
    v_mov_b64 v[2:3], 0
    v_mov_b64 v[60:61], 0
    ds_read_b64_tr_b16 v[14:15], v54 offset:32
    ds_read_b64_tr_b16 v[16:17], v54 offset:2592
    ds_read_b64_tr_b16 v[18:19], v54 offset:5152
    ds_read_b64_tr_b16 v[20:21], v54 offset:7712
    ds_read_b64_tr_b16 v[22:23], v54 offset:10272
    ds_read_b64_tr_b16 v[24:25], v54 offset:12832
    ds_read_b64_tr_b16 v[26:27], v54 offset:15392
    ds_read_b64_tr_b16 v[28:29], v54 offset:17952
    s_waitcnt lgkmcnt(0)
    s_barrier
    ds_read_b128 v[6:9], v55
    ds_read_b128 v[10:13], v55 offset:128
    ds_read_b128 a[236:239], v55 offset:256
    s_waitcnt lgkmcnt(2)
    v_smfmac_f32_16x16x64_bf16 v[60:63], v[6:9], v[30:37], v1
    ds_read_b64_tr_b16 v[30:31], v54 offset:20512
    ds_read_b64_tr_b16 v[32:33], v54 offset:23072
    ds_read_b64_tr_b16 v[34:35], v54 offset:25632
    ds_read_b64_tr_b16 v[36:37], v54 offset:28192
    v_smfmac_f32_16x16x64_bf16 v[2:5], v[6:9], v[14:21], v1
    s_waitcnt lgkmcnt(5)
    v_smfmac_f32_16x16x64_bf16 v[60:63], v[10:13], v[38:45], v1
    v_lshrrev_b32 v6, 4, v0
    v_mul_u32_u24 v6, 3968, v6
    v_smfmac_f32_16x16x64_bf16 v[2:5], v[10:13], v[22:29], v1
    v_lshl_add_u32 v6, v0, 2, v6
    s_waitcnt lgkmcnt(4)
    v_smfmac_f32_16x16x64_bf16 v[60:63], a[236:239], v[46:53], v1
    s_waitcnt lgkmcnt(0)
    v_smfmac_f32_16x16x64_bf16 v[2:5], a[236:239], v[30:37], v1
    s_mov_b64 exec, s[50:51]
    s_nop 4
    v_add_f32_dpp v7, v60, v61 quad_perm:[0,1,2,3] row_mask:0x1 bank_mask:0xf
    s_nop 0
    v_add_f32_dpp v7, v2, v3 quad_perm:[0,1,2,3] row_mask:0x2 bank_mask:0xf
    buffer_store_dword v7, v6, s[20:23], s45 offen sc1
    s_mov_b64 exec, -1
    s_branch Lr_217
Lcold_228:
    s_cmp_ge_u32 s53, 40
    s_cbranch_scc1 Lex_229
    s_waitcnt lgkmcnt(0)
    buffer_load_dwordx4 v[6:9], v54, s[20:23], s46 offen offset:0 sc1
    buffer_load_dwordx4 v[10:13], v54, s[20:23], s46 offen offset:1024 sc1
    buffer_load_dwordx4 v[14:17], v54, s[20:23], s46 offen offset:2048 sc1
    buffer_load_dwordx4 v[18:21], v54, s[20:23], s46 offen offset:3072 sc1
    s_add_u32 s53, s53, 1
    s_waitcnt vmcnt(0)
    s_branch Lc_226
Lex_229:
    s_cmp_gt_u32 s53, 40
    s_cbranch_scc1 Lok_227
    s_waitcnt lgkmcnt(0)
    s_mov_b32 s48, 0
Lpoll_230:
    buffer_load_dwordx4 v[6:9], v54, s[20:23], s46 offen offset:0 sc1
    buffer_load_dwordx4 v[10:13], v54, s[20:23], s46 offen offset:1024 sc1
    buffer_load_dwordx4 v[14:17], v54, s[20:23], s46 offen offset:2048 sc1
    buffer_load_dwordx4 v[18:21], v54, s[20:23], s46 offen offset:3072 sc1
    s_waitcnt vmcnt(0)
    v_max3_u32 v3, v6, v7, v8
    v_max3_u32 v3, v3, v9, v10
    v_max3_u32 v3, v3, v11, v12
    v_max3_u32 v3, v3, v13, v14
    v_max3_u32 v3, v3, v15, v16
    v_max3_u32 v3, v3, v17, v18
    v_max3_u32 v3, v3, v19, v20
    v_max_u32 v3, v3, v21
    v_cmp_eq_u32 vcc, -1, v3
    s_cbranch_vccz Lgot_231
    s_add_u32 s48, s48, 1
    s_cmp_lt_u32 s48, s47
    s_cbranch_scc1 Lpoll_230
    s_mov_b32 s47, 0
Lgot_231:
    s_add_u32 s53, s53, 1
    s_branch Lc_226
Lx_224:
    s_branch Lr_225
Lcold_234:
    s_cmp_ge_u32 s53, 40
    s_cbranch_scc1 Lex_235
    s_waitcnt lgkmcnt(0)
    buffer_load_dwordx4 v[6:9], v54, s[20:23], s46 offen offset:0 sc1
    buffer_load_dwordx4 v[10:13], v54, s[20:23], s46 offen offset:1024 sc1
    buffer_load_dwordx4 v[14:17], v54, s[20:23], s46 offen offset:2048 sc1
    buffer_load_dwordx4 v[18:21], v54, s[20:23], s46 offen offset:3072 sc1
    s_add_u32 s53, s53, 1
    s_waitcnt vmcnt(0)
    s_branch Lc_232
Lex_235:
    s_cmp_gt_u32 s53, 40
    s_cbranch_scc1 Lok_233
    s_waitcnt lgkmcnt(0)
    s_mov_b32 s48, 0
Lpoll_236:
    buffer_load_dwordx4 v[6:9], v54, s[20:23], s46 offen offset:0 sc1
    buffer_load_dwordx4 v[10:13], v54, s[20:23], s46 offen offset:1024 sc1
    buffer_load_dwordx4 v[14:17], v54, s[20:23], s46 offen offset:2048 sc1
    buffer_load_dwordx4 v[18:21], v54, s[20:23], s46 offen offset:3072 sc1
    s_waitcnt vmcnt(0)
    v_max3_u32 v3, v6, v7, v8
    v_max3_u32 v3, v3, v9, v10
    v_max3_u32 v3, v3, v11, v12
    v_max3_u32 v3, v3, v13, v14
    v_max3_u32 v3, v3, v15, v16
    v_max3_u32 v3, v3, v17, v18
    v_max3_u32 v3, v3, v19, v20
    v_max_u32 v3, v3, v21
    v_cmp_eq_u32 vcc, -1, v3
    s_cbranch_vccz Lgot_237
    s_add_u32 s48, s48, 1
    s_cmp_lt_u32 s48, s47
    s_cbranch_scc1 Lpoll_236
    s_mov_b32 s47, 0
Lgot_237:
    s_add_u32 s53, s53, 1
    s_branch Lc_232
L_last:
L_end:
    s_endpgm
.section .rodata,"a"
.p2align 6
.amdhsa_kernel interleave_layers__gqa_block_cached__compressed_kv_cla__decode_kernel
  .amdhsa_next_free_vgpr 512
  .amdhsa_next_free_sgpr 102
  .amdhsa_accum_offset 256
  .amdhsa_group_segment_fixed_size 0
  .amdhsa_kernarg_size 112
  .amdhsa_user_sgpr_count 2
  .amdhsa_user_sgpr_kernarg_segment_ptr 1
  .amdhsa_system_sgpr_workgroup_id_x 1
.end_amdhsa_kernel
```
